```python
import torch

def _softmax(x, axis=-1):
    return torch.softmax(x, dim=axis)
def _gelu(x):
    return torch.nn.functional.gelu(x, approximate="tanh")
def _silu(x):
    return torch.nn.functional.silu(x)
def _sigmoid(x):
    return torch.sigmoid(x)
def _layernorm(x, axis=-1, eps=1e-5):
    m = x.mean(dim=axis, keepdim=True)
    v = x.var(dim=axis, keepdim=True, unbiased=False)
    return (x - m) / torch.sqrt(v + eps)
def _scatter_add(tgt, idx, src, axis=0):
    return tgt.clone().index_add_(axis, idx, src)
def _segment_sum(src, seg, n):
    out = torch.zeros((n,) + src.shape[1:], dtype=src.dtype)
    return out.index_add_(0, seg, src)
def _pad(x, pw):
    flat = tuple(v for pair in reversed(pw) for v in pair)
    return torch.nn.functional.pad(x, flat)

kernel_name = 'standalone__sliding_block_cached__sampling'

def setup_inputs():

    _w = (lambda a: (lambda t: t.to(torch.bfloat16) if t.is_floating_point() else t)(torch.as_tensor(a)))
    B, Sq, D = 8, 32, 576
    Hq, Hkv, Sk, Dh = 32, 16, 8192, 128
    assert Hq % Hkv == 0, (Hq, Hkv)
    return {
        "x": _w((lambda *s: torch.randn(*s, dtype=torch.bfloat16) * 0.8)(B, Sq, D)),
        "k_cache": _w((lambda *s: torch.randn(*s, dtype=torch.bfloat16) * 0.8)(B, Hkv, Sk, Dh)),
        "v_cache": _w((lambda *s: torch.randn(*s, dtype=torch.bfloat16) * 0.05)(B, Hkv, Sk, Dh)),
        "wq": _w((lambda *s: torch.randn(*s, dtype=torch.bfloat16) * 0.8)(D, Hq * Dh) * (D ** -0.5)),
        "wo": _w((lambda *s: torch.randn(*s, dtype=torch.bfloat16) * 0.05)(Hq * Dh, D) * ((Hq * Dh) ** -0.5)),
    }

def reference(x, k_cache, v_cache, wq, wo):
    B, Sq, D = x.shape
    Hq, Dh = 32, 128
    Hkv, Sk = k_cache.shape[1], k_cache.shape[2]
    W = min(4096, max(256, Sk // 4))
    rep = Hq // Hkv
    q = (lambda x, *d: x.permute(*d))((x @ wq).reshape(B, Sq, Hq, Dh), 0, 2, 1, 3)
    k = (lambda x, n, axis: torch.repeat_interleave(x, n, dim=axis))(k_cache[:, :, Sk - W:, :], rep, axis=1)
    v = (lambda x, n, axis: torch.repeat_interleave(x, n, dim=axis))(v_cache[:, :, Sk - W:, :], rep, axis=1)
    scores = torch.einsum("bhqd,bhkd->bhqk", q, k) * (Dh ** -0.5)
    p = _softmax(scores, axis=-1)
    o = torch.einsum("bhqk,bhkd->bhqd", p, v)
    return (lambda x, *d: x.permute(*d))(o, 0, 2, 1, 3).reshape(B, Sq, Hq * Dh) @ wo
```

```asm
; @launch grid=(256,1,1) block=(512,1,1) lds=157760
.amdgcn_target "amdgcn-amd-amdhsa--gfx950"
.text
.globl standalone__sliding_block_cached__sampling_kernel
.p2align 8
.type standalone__sliding_block_cached__sampling_kernel,@function
standalone__sliding_block_cached__sampling_kernel:
  s_cmp_ge_u32 s2, 256
  s_cbranch_scc1 L_end1
  s_load_dwordx16 s[4:19], s[0:1], 0
  v_lshrrev_b32 v28, 6, v0
  v_and_b32 v0, 63, v0
  v_readfirstlane_b32 s48, v28
  s_and_b32 s49, s2, 7
  s_lshl_b32 s49, s49, 1
  s_bfe_u32 s53, s2, 0x10003
  s_or_b32 s49, s49, s53
  s_lshr_b32 s50, s2, 5
  v_lshrrev_b32 v28, 5, v0
  v_and_b32 v29, 31, v0
  v_lshlrev_b32 v30, 2, v28
  v_xor_b32 v29, v29, v30
  v_lshlrev_b32 v29, 4, v29
  v_lshl_add_u32 v32, v28, 13, v29
  v_xor_b32 v33, 0x80, v32
  v_add_u32 v33, 15360, v33
  s_lshl_b32 s52, s48, 11
  s_lshl_b32 s57, s48, 15
  s_lshl_b32 s54, s49, 9
  s_add_u32 s57, s57, s54
  s_bfe_u32 s62, s2, 0x20003
  s_lshl1_add_u32 s62, s62, s50
  s_cmp_ge_u32 s62, 9
  s_cselect_b32 s54, 9, 0
  s_sub_u32 s62, s62, s54
  s_mov_b32 s59, s62
  s_and_b32 s98, s48, 3
  s_lshr_b32 s99, s48, 2
  v_lshrrev_b32 v28, 3, v0
  v_lshrrev_b32 v3, 4, v0
  s_and_b32 s54, s48, 1
  s_lshl_b32 s54, s54, 2
  v_or_b32 v29, s54, v3
  v_and_b32 v30, 7, v0
  v_xor_b32 v29, v29, v30
  s_movk_i32 s54, 1152
  v_mul_lo_u32 v28, v28, s54
  v_lshl_add_u32 v34, v29, 4, v28
  s_mul_i32 s101, s50, 36864
  s_mul_i32 s53, s98, 9216
  s_add_u32 s101, s101, s53
  s_add_u32 s100, s62, s99
  s_cmp_eq_u32 s100, 9
  s_cselect_b32 s100, 0, s100
  s_lshl_b32 s55, s98, 10
  s_add_u32 s55, s55, 114688
  s_lshl_b32 s65, s48, 10
  s_waitcnt lgkmcnt(0)
  s_mov_b32 s32, s4
  s_mov_b32 s33, s5
  s_mov_b32 s34, 294912
  s_mov_b32 s35, 0x20000
  s_mov_b32 s28, s10
  s_mov_b32 s29, s11
  s_mov_b32 s30, 4718592
  s_mov_b32 s31, 0x20000
  v_and_b32 v2, 15, v0
  s_lshl_b32 s54, s100, 12
  s_add_u32 m0, s54, s55
  s_lshl_b32 s54, s100, 7
  s_add_u32 s54, s54, s101
  buffer_load_dwordx4 v34, s[32:35], s54 offen lds
  s_add_u32 s100, s100, 2
  s_cmp_ge_u32 s100, 9
  s_cselect_b32 s54, 9, 0
  s_sub_u32 s100, s100, s54
  s_add_u32 m0, s52, 98304
  s_lshl_b32 s63, s62, 19
  s_add_u32 s63, s63, s57
  buffer_load_dwordx4 v32, s[28:31], s63 offen offset:0 lds
  buffer_load_dwordx4 v33, s[28:31], s63 offen offset:1024 lds
  s_add_u32 m0, s52, 81920
  s_add_u32 s63, s63, 262144
  buffer_load_dwordx4 v32, s[28:31], s63 offen offset:0 lds
  buffer_load_dwordx4 v33, s[28:31], s63 offen offset:1024 lds
  s_add_u32 s62, s62, 1
  s_cmp_eq_u32 s62, 9
  s_cselect_b32 s62, 0, s62
  s_bfe_u32 s51, s2, 0x10004
  s_lshl_b32 s53, s50, 4
  s_add_u32 s53, s53, s49
  s_lshl_b32 s53, s53, 21
  s_lshl_b32 s54, s51, 18
  s_add_u32 s53, s53, s54
  s_add_u32 s53, s53, 1572864
  s_add_u32 s20, s6, s53
  s_addc_u32 s21, s7, 0
  s_mov_b32 s22, 0x40000
  s_mov_b32 s23, 0x20000
  s_add_u32 s24, s8, s53
  s_addc_u32 s25, s9, 0
  s_mov_b32 s26, 0x40000
  s_mov_b32 s27, 0x20000
  s_and_b32 s54, s48, 1
  s_lshl_b32 s54, s54, 3
  v_xor_b32 v28, v3, v2
  v_xor_b32 v28, s54, v28
  v_lshlrev_b32 v28, 4, v28
  v_lshl_add_u32 v4, v3, 8, v28
  v_xor_b32 v5, 64, v4
  s_bitcmp1_b32 s2, 5
  s_cbranch_scc0 Lr_1
  s_barrier
  s_add_u32 s54, s52, 0
  buffer_load_dwordx4 v[128:131], v4, s[20:23], s54 offen offset:0 nt
  buffer_load_dwordx4 v[132:135], v5, s[20:23], s54 offen offset:1024 nt
  s_add_u32 s54, s52, 16384
  buffer_load_dwordx4 v[136:139], v4, s[20:23], s54 offen offset:0 nt
  buffer_load_dwordx4 v[140:143], v5, s[20:23], s54 offen offset:1024 nt
  s_add_u32 s54, s52, 32768
  buffer_load_dwordx4 v[144:147], v4, s[20:23], s54 offen offset:0 nt
  buffer_load_dwordx4 v[148:151], v5, s[20:23], s54 offen offset:1024 nt
  s_add_u32 s54, s52, 49152
  buffer_load_dwordx4 v[152:155], v4, s[20:23], s54 offen offset:0 nt
  buffer_load_dwordx4 v[156:159], v5, s[20:23], s54 offen offset:1024 nt
  s_add_u32 s54, s52, 65536
  buffer_load_dwordx4 v[160:163], v4, s[20:23], s54 offen offset:0 nt
  buffer_load_dwordx4 v[164:167], v5, s[20:23], s54 offen offset:1024 nt
  s_add_u32 s54, s52, 81920
  buffer_load_dwordx4 v[168:171], v4, s[20:23], s54 offen offset:0 nt
  buffer_load_dwordx4 v[172:175], v5, s[20:23], s54 offen offset:1024 nt
  s_add_u32 s54, s52, 98304
  buffer_load_dwordx4 v[176:179], v4, s[20:23], s54 offen offset:0 nt
  buffer_load_dwordx4 v[180:183], v5, s[20:23], s54 offen offset:1024 nt
  s_add_u32 s54, s52, 114688
  buffer_load_dwordx4 v[184:187], v4, s[20:23], s54 offen offset:0 nt
  buffer_load_dwordx4 v[188:191], v5, s[20:23], s54 offen offset:1024 nt
  s_barrier
Lr_1:
  s_add_u32 m0, s52, 65536
  s_lshl_b32 s63, s62, 19
  s_add_u32 s63, s63, s57
  buffer_load_dwordx4 v32, s[28:31], s63 offen offset:0 lds
  buffer_load_dwordx4 v33, s[28:31], s63 offen offset:1024 lds
  v_lshlrev_b32 v1, 4, v0
  v_add_u32 v35, s52, v1
  v_lshrrev_b32 v28, 2, v2
  v_xor_b32 v29, s48, v28
  v_lshlrev_b32 v29, 6, v29
  v_lshl_add_u32 v29, v28, 9, v29
  v_lshrrev_b32 v30, 5, v0
  v_lshl_add_u32 v29, v30, 12, v29
  v_and_b32 v31, 1, v3
  v_lshl_add_u32 v29, v31, 5, v29
  v_and_b32 v31, 3, v2
  v_lshl_add_u32 v36, v31, 3, v29
  v_add_u32 v37, 0x10000, v36
  v_and_b32 v28, 31, v0
  v_bfe_u32 v29, v0, 1, 3
  v_xor_b32 v29, v29, v30
  v_lshlrev_b32 v29, 4, v29
  v_lshl_add_u32 v38, v28, 7, v29
  v_xor_b32 v39, 32, v38
  v_xor_b32 v40, 64, v38
  v_xor_b32 v41, 96, v38
  s_lshl_b32 s54, s59, 12
  s_add_u32 s54, s54, 114688
  v_add_u32 v42, s54, v38
  v_add_u32 v43, s54, v39
  v_add_u32 v44, s54, v40
  v_add_u32 v45, s54, v41
  s_add_u32 s59, s59, 1
  s_cmp_eq_u32 s59, 9
  s_cselect_b32 s59, 0, s59
  s_waitcnt vmcnt(18)
  s_bitcmp1_b32 s2, 5
  s_cbranch_scc1 Lr_2
  s_waitcnt vmcnt(2)
Lr_2:
  s_add_u32 m0, s52, 49152
  s_add_u32 s63, s63, 262144
  buffer_load_dwordx4 v32, s[28:31], s63 offen offset:0 lds
  buffer_load_dwordx4 v33, s[28:31], s63 offen offset:1024 lds
  s_add_u32 s62, s62, 1
  s_cmp_eq_u32 s62, 9
  s_cselect_b32 s62, 0, s62
  s_lshl_b32 s54, s100, 12
  s_add_u32 m0, s54, s55
  s_lshl_b32 s54, s100, 7
  s_add_u32 s54, s54, s101
  buffer_load_dwordx4 v34, s[32:35], s54 offen lds
  s_add_u32 s100, s100, 2
  s_cmp_ge_u32 s100, 9
  s_cselect_b32 s54, 9, 0
  s_sub_u32 s100, s100, s54
  s_add_u32 m0, s52, 32768
  s_lshl_b32 s63, s62, 19
  s_add_u32 s63, s63, s57
  buffer_load_dwordx4 v32, s[28:31], s63 offen offset:0 lds
  buffer_load_dwordx4 v33, s[28:31], s63 offen offset:1024 lds
  s_add_u32 m0, s52, 16384
  s_add_u32 s63, s63, 262144
  buffer_load_dwordx4 v32, s[28:31], s63 offen offset:0 lds
  buffer_load_dwordx4 v33, s[28:31], s63 offen offset:1024 lds
  s_add_u32 s62, s62, 1
  s_cmp_eq_u32 s62, 9
  s_cselect_b32 s62, 0, s62
  s_add_u32 m0, s52, 0
  s_lshl_b32 s63, s62, 19
  s_add_u32 s63, s63, s57
  buffer_load_dwordx4 v32, s[28:31], s63 offen offset:0 lds
  buffer_load_dwordx4 v33, s[28:31], s63 offen offset:1024 lds
  s_barrier
  ds_read_b64_tr_b16 v[48:49], v37 offset:32768
  ds_read_b64_tr_b16 v[50:51], v37 offset:34816
  ds_read_b128 v[64:67], v42
  ds_read_b64_tr_b16 v[52:53], v37 offset:40960
  ds_read_b64_tr_b16 v[54:55], v37 offset:43008
  ds_read_b128 v[68:71], v43
  ds_read_b64_tr_b16 v[56:57], v37 offset:16384
  ds_read_b64_tr_b16 v[58:59], v37 offset:18432
  ds_read_b128 v[72:75], v44
  ds_read_b64_tr_b16 v[60:61], v37 offset:24576
  ds_read_b64_tr_b16 v[62:63], v37 offset:26624
  ds_read_b128 v[76:79], v45
  s_lshl_b32 s54, s59, 12
  s_add_u32 s54, s54, 114688
  v_add_u32 v42, s54, v38
  v_add_u32 v43, s54, v39
  v_add_u32 v44, s54, v40
  v_add_u32 v45, s54, v41
  s_add_u32 s59, s59, 1
  s_cmp_eq_u32 s59, 9
  s_cselect_b32 s59, 0, s59
  s_waitcnt vmcnt(7)
  s_waitcnt lgkmcnt(0)
  s_barrier
  s_add_u32 m0, s52, 98304
  s_add_u32 s63, s63, 262144
  buffer_load_dwordx4 v32, s[28:31], s63 offen offset:0 lds
  buffer_load_dwordx4 v33, s[28:31], s63 offen offset:1024 lds
  s_add_u32 s62, s62, 1
  s_cmp_eq_u32 s62, 9
  s_cselect_b32 s62, 0, s62
  s_lshl_b32 s54, s100, 12
  s_add_u32 m0, s54, s55
  s_lshl_b32 s54, s100, 7
  s_add_u32 s54, s54, s101
  buffer_load_dwordx4 v34, s[32:35], s54 offen lds
  s_add_u32 s100, s100, 2
  s_cmp_ge_u32 s100, 9
  s_cselect_b32 s54, 9, 0
  s_sub_u32 s100, s100, s54
  s_add_u32 m0, s52, 81920
  s_lshl_b32 s63, s62, 19
  s_add_u32 s63, s63, s57
  buffer_load_dwordx4 v32, s[28:31], s63 offen offset:0 lds
  buffer_load_dwordx4 v33, s[28:31], s63 offen offset:1024 lds
  ds_read_b64_tr_b16 v[80:81], v37 offset:0
  ds_read_b64_tr_b16 v[82:83], v37 offset:2048
  ds_read_b128 v[96:99], v42
  ds_read_b64_tr_b16 v[84:85], v37 offset:8192
  ds_read_b64_tr_b16 v[86:87], v37 offset:10240
  ds_read_b128 v[100:103], v43
  ds_read_b64_tr_b16 v[88:89], v36 offset:49152
  ds_read_b64_tr_b16 v[90:91], v36 offset:51200
  ds_read_b128 v[104:107], v44
  ds_read_b64_tr_b16 v[92:93], v36 offset:57344
  ds_read_b64_tr_b16 v[94:95], v36 offset:59392
  ds_read_b128 v[108:111], v45
  v_mfma_f32_32x32x16_bf16 v[112:127], v[48:51], v[64:67], 0
  v_mfma_f32_32x32x16_bf16 v[112:127], v[52:55], v[68:71], v[112:127]
  v_mfma_f32_32x32x16_bf16 v[112:127], v[56:59], v[72:75], v[112:127]
  v_mfma_f32_32x32x16_bf16 v[112:127], v[60:63], v[76:79], v[112:127]
  s_lshl_b32 s54, s59, 12
  s_add_u32 s54, s54, 114688
  v_add_u32 v42, s54, v38
  v_add_u32 v43, s54, v39
  v_add_u32 v44, s54, v40
  v_add_u32 v45, s54, v41
  s_add_u32 s59, s59, 1
  s_cmp_eq_u32 s59, 9
  s_cselect_b32 s59, 0, s59
  s_waitcnt vmcnt(7)
  s_waitcnt lgkmcnt(0)
  s_barrier
  s_add_u32 m0, s52, 65536
  s_add_u32 s63, s63, 262144
  buffer_load_dwordx4 v32, s[28:31], s63 offen offset:0 lds
  buffer_load_dwordx4 v33, s[28:31], s63 offen offset:1024 lds
  s_add_u32 s62, s62, 1
  s_cmp_eq_u32 s62, 9
  s_cselect_b32 s62, 0, s62
  s_add_u32 m0, s52, 49152
  s_lshl_b32 s63, s62, 19
  s_add_u32 s63, s63, s57
  buffer_load_dwordx4 v32, s[28:31], s63 offen offset:0 lds
  buffer_load_dwordx4 v33, s[28:31], s63 offen offset:1024 lds
  ds_read_b64_tr_b16 v[48:49], v36 offset:32768
  ds_read_b64_tr_b16 v[50:51], v36 offset:34816
  ds_read_b128 v[64:67], v42
  ds_read_b64_tr_b16 v[52:53], v36 offset:40960
  ds_read_b64_tr_b16 v[54:55], v36 offset:43008
  ds_read_b128 v[68:71], v43
  ds_read_b64_tr_b16 v[56:57], v36 offset:16384
  ds_read_b64_tr_b16 v[58:59], v36 offset:18432
  ds_read_b128 v[72:75], v44
  ds_read_b64_tr_b16 v[60:61], v36 offset:24576
  ds_read_b64_tr_b16 v[62:63], v36 offset:26624
  ds_read_b128 v[76:79], v45
  v_mfma_f32_32x32x16_bf16 v[112:127], v[80:83], v[96:99], v[112:127]
  v_mfma_f32_32x32x16_bf16 v[112:127], v[84:87], v[100:103], v[112:127]
  v_mfma_f32_32x32x16_bf16 v[112:127], v[88:91], v[104:107], v[112:127]
  v_mfma_f32_32x32x16_bf16 v[112:127], v[92:95], v[108:111], v[112:127]
  s_lshl_b32 s54, s59, 12
  s_add_u32 s54, s54, 114688
  v_add_u32 v42, s54, v38
  v_add_u32 v43, s54, v39
  v_add_u32 v44, s54, v40
  v_add_u32 v45, s54, v41
  s_add_u32 s59, s59, 1
  s_cmp_eq_u32 s59, 9
  s_cselect_b32 s59, 0, s59
  s_waitcnt vmcnt(7)
  s_waitcnt lgkmcnt(0)
  s_barrier
  s_add_u32 m0, s52, 32768
  s_add_u32 s63, s63, 262144
  buffer_load_dwordx4 v32, s[28:31], s63 offen offset:0 lds
  buffer_load_dwordx4 v33, s[28:31], s63 offen offset:1024 lds
  s_add_u32 s62, s62, 1
  s_cmp_eq_u32 s62, 9
  s_cselect_b32 s62, 0, s62
  s_lshl_b32 s54, s100, 12
  s_add_u32 m0, s54, s55
  s_lshl_b32 s54, s100, 7
  s_add_u32 s54, s54, s101
  buffer_load_dwordx4 v34, s[32:35], s54 offen lds
  s_add_u32 s100, s100, 2
  s_cmp_ge_u32 s100, 9
  s_cselect_b32 s54, 9, 0
  s_sub_u32 s100, s100, s54
  s_add_u32 m0, s52, 16384
  s_lshl_b32 s63, s62, 19
  s_add_u32 s63, s63, s57
  buffer_load_dwordx4 v32, s[28:31], s63 offen offset:0 lds
  buffer_load_dwordx4 v33, s[28:31], s63 offen offset:1024 lds
  ds_read_b64_tr_b16 v[80:81], v36 offset:0
  ds_read_b64_tr_b16 v[82:83], v36 offset:2048
  ds_read_b128 v[96:99], v42
  ds_read_b64_tr_b16 v[84:85], v36 offset:8192
  ds_read_b64_tr_b16 v[86:87], v36 offset:10240
  ds_read_b128 v[100:103], v43
  ds_read_b64_tr_b16 v[88:89], v37 offset:32768
  ds_read_b64_tr_b16 v[90:91], v37 offset:34816
  ds_read_b128 v[104:107], v44
  ds_read_b64_tr_b16 v[92:93], v37 offset:40960
  ds_read_b64_tr_b16 v[94:95], v37 offset:43008
  ds_read_b128 v[108:111], v45
  v_mfma_f32_32x32x16_bf16 v[112:127], v[48:51], v[64:67], v[112:127]
  v_mfma_f32_32x32x16_bf16 v[112:127], v[52:55], v[68:71], v[112:127]
  v_mfma_f32_32x32x16_bf16 v[112:127], v[56:59], v[72:75], v[112:127]
  v_mfma_f32_32x32x16_bf16 v[112:127], v[60:63], v[76:79], v[112:127]
  s_lshl_b32 s54, s59, 12
  s_add_u32 s54, s54, 114688
  v_add_u32 v42, s54, v38
  v_add_u32 v43, s54, v39
  v_add_u32 v44, s54, v40
  v_add_u32 v45, s54, v41
  s_add_u32 s59, s59, 1
  s_cmp_eq_u32 s59, 9
  s_cselect_b32 s59, 0, s59
  s_waitcnt vmcnt(7)
  s_waitcnt lgkmcnt(0)
  s_barrier
  s_add_u32 m0, s52, 98304
  s_add_u32 s63, s63, 262144
  buffer_load_dwordx4 v32, s[28:31], s63 offen offset:0 lds
  buffer_load_dwordx4 v33, s[28:31], s63 offen offset:1024 lds
  s_add_u32 s62, s62, 1
  s_cmp_eq_u32 s62, 9
  s_cselect_b32 s62, 0, s62
  s_add_u32 m0, s52, 0
  s_lshl_b32 s63, s62, 19
  s_add_u32 s63, s63, s57
  buffer_load_dwordx4 v32, s[28:31], s63 offen offset:0 lds
  buffer_load_dwordx4 v33, s[28:31], s63 offen offset:1024 lds
  ds_read_b64_tr_b16 v[48:49], v37 offset:16384
  ds_read_b64_tr_b16 v[50:51], v37 offset:18432
  ds_read_b128 v[64:67], v42
  ds_read_b64_tr_b16 v[52:53], v37 offset:24576
  ds_read_b64_tr_b16 v[54:55], v37 offset:26624
  ds_read_b128 v[68:71], v43
  ds_read_b64_tr_b16 v[56:57], v37 offset:0
  ds_read_b64_tr_b16 v[58:59], v37 offset:2048
  ds_read_b128 v[72:75], v44
  ds_read_b64_tr_b16 v[60:61], v37 offset:8192
  ds_read_b64_tr_b16 v[62:63], v37 offset:10240
  ds_read_b128 v[76:79], v45
  v_mfma_f32_32x32x16_bf16 v[112:127], v[80:83], v[96:99], v[112:127]
  v_mfma_f32_32x32x16_bf16 v[112:127], v[84:87], v[100:103], v[112:127]
  v_mfma_f32_32x32x16_bf16 v[112:127], v[88:91], v[104:107], v[112:127]
  v_mfma_f32_32x32x16_bf16 v[112:127], v[92:95], v[108:111], v[112:127]
  s_lshl_b32 s54, s59, 12
  s_add_u32 s54, s54, 114688
  v_add_u32 v42, s54, v38
  v_add_u32 v43, s54, v39
  v_add_u32 v44, s54, v40
  v_add_u32 v45, s54, v41
  s_add_u32 s59, s59, 1
  s_cmp_eq_u32 s59, 9
  s_cselect_b32 s59, 0, s59
  s_waitcnt vmcnt(7)
  s_waitcnt lgkmcnt(0)
  s_barrier
  s_add_u32 m0, s52, 81920
  s_add_u32 s63, s63, 262144
  buffer_load_dwordx4 v32, s[28:31], s63 offen offset:0 lds
  buffer_load_dwordx4 v33, s[28:31], s63 offen offset:1024 lds
  s_add_u32 s62, s62, 1
  s_cmp_eq_u32 s62, 9
  s_cselect_b32 s62, 0, s62
  s_lshl_b32 s54, s100, 12
  s_add_u32 m0, s54, s55
  s_lshl_b32 s54, s100, 7
  s_add_u32 s54, s54, s101
  buffer_load_dwordx4 v34, s[32:35], s54 offen lds
  s_add_u32 m0, s52, 65536
  s_lshl_b32 s63, s62, 19
  s_add_u32 s63, s63, s57
  buffer_load_dwordx4 v32, s[28:31], s63 offen offset:0 lds
  buffer_load_dwordx4 v33, s[28:31], s63 offen offset:1024 lds
  ds_read_b64_tr_b16 v[80:81], v36 offset:49152
  ds_read_b64_tr_b16 v[82:83], v36 offset:51200
  ds_read_b128 v[96:99], v42
  ds_read_b64_tr_b16 v[84:85], v36 offset:57344
  ds_read_b64_tr_b16 v[86:87], v36 offset:59392
  ds_read_b128 v[100:103], v43
  ds_read_b64_tr_b16 v[88:89], v36 offset:32768
  ds_read_b64_tr_b16 v[90:91], v36 offset:34816
  ds_read_b128 v[104:107], v44
  ds_read_b64_tr_b16 v[92:93], v36 offset:40960
  ds_read_b64_tr_b16 v[94:95], v36 offset:43008
  ds_read_b128 v[108:111], v45
  v_mfma_f32_32x32x16_bf16 v[112:127], v[48:51], v[64:67], v[112:127]
  v_mfma_f32_32x32x16_bf16 v[112:127], v[52:55], v[68:71], v[112:127]
  v_mfma_f32_32x32x16_bf16 v[112:127], v[56:59], v[72:75], v[112:127]
  v_mfma_f32_32x32x16_bf16 v[112:127], v[60:63], v[76:79], v[112:127]
  s_lshl_b32 s54, s59, 12
  s_add_u32 s54, s54, 114688
  v_add_u32 v42, s54, v38
  v_add_u32 v43, s54, v39
  v_add_u32 v44, s54, v40
  v_add_u32 v45, s54, v41
  s_add_u32 s59, s59, 1
  s_cmp_eq_u32 s59, 9
  s_cselect_b32 s59, 0, s59
  s_waitcnt vmcnt(7)
  s_waitcnt lgkmcnt(0)
  s_barrier
  s_add_u32 m0, s52, 49152
  s_add_u32 s63, s63, 262144
  buffer_load_dwordx4 v32, s[28:31], s63 offen offset:0 lds
  buffer_load_dwordx4 v33, s[28:31], s63 offen offset:1024 lds
  ds_read_b64_tr_b16 v[48:49], v36 offset:16384
  ds_read_b64_tr_b16 v[50:51], v36 offset:18432
  ds_read_b128 v[64:67], v42
  ds_read_b64_tr_b16 v[52:53], v36 offset:24576
  ds_read_b64_tr_b16 v[54:55], v36 offset:26624
  ds_read_b128 v[68:71], v43
  ds_read_b64_tr_b16 v[56:57], v37 offset:32768
  ds_read_b64_tr_b16 v[58:59], v37 offset:34816
  ds_read_b128 v[72:75], v44
  ds_read_b64_tr_b16 v[60:61], v37 offset:40960
  ds_read_b64_tr_b16 v[62:63], v37 offset:43008
  ds_read_b128 v[76:79], v45
  v_mfma_f32_32x32x16_bf16 v[112:127], v[80:83], v[96:99], v[112:127]
  v_mfma_f32_32x32x16_bf16 v[112:127], v[84:87], v[100:103], v[112:127]
  v_mfma_f32_32x32x16_bf16 v[112:127], v[88:91], v[104:107], v[112:127]
  v_mfma_f32_32x32x16_bf16 v[112:127], v[92:95], v[108:111], v[112:127]
  s_bitcmp1_b32 s2, 5
  s_cbranch_scc1 Lr_3
  s_add_u32 s54, s52, 0
  buffer_load_dwordx4 v[128:131], v4, s[20:23], s54 offen offset:0 nt
  buffer_load_dwordx4 v[132:135], v5, s[20:23], s54 offen offset:1024 nt
  s_add_u32 s54, s52, 16384
  buffer_load_dwordx4 v[136:139], v4, s[20:23], s54 offen offset:0 nt
  buffer_load_dwordx4 v[140:143], v5, s[20:23], s54 offen offset:1024 nt
Lr_3:
  s_bitcmp1_b32 s2, 5
  s_cbranch_scc0 Lr_4
  s_add_u32 m0, s52, 32768
  s_add_u32 s54, s52, 131072
  buffer_load_dwordx4 v4, s[20:23], s54 offen offset:0 nt lds
  buffer_load_dwordx4 v5, s[20:23], s54 offen offset:1024 nt lds
Lr_4:
  s_lshl_b32 s54, s59, 12
  s_add_u32 s54, s54, 114688
  v_add_u32 v42, s54, v38
  v_add_u32 v43, s54, v39
  v_add_u32 v44, s54, v40
  v_add_u32 v45, s54, v41
  s_add_u32 s59, s59, 1
  s_cmp_eq_u32 s59, 9
  s_cselect_b32 s59, 0, s59
  s_waitcnt vmcnt(9)
  s_bitcmp1_b32 s2, 5
  s_cbranch_scc0 Lr_5
  s_waitcnt vmcnt(7)
Lr_5:
  s_waitcnt lgkmcnt(0)
  s_barrier
  ds_read_b64_tr_b16 v[80:81], v36 offset:0
  ds_read_b64_tr_b16 v[82:83], v36 offset:2048
  ds_read_b128 v[96:99], v42
  ds_read_b64_tr_b16 v[84:85], v36 offset:8192
  ds_read_b64_tr_b16 v[86:87], v36 offset:10240
  ds_read_b128 v[100:103], v43
  ds_read_b64_tr_b16 v[88:89], v37 offset:16384
  ds_read_b64_tr_b16 v[90:91], v37 offset:18432
  ds_read_b128 v[104:107], v44
  ds_read_b64_tr_b16 v[92:93], v37 offset:24576
  ds_read_b64_tr_b16 v[94:95], v37 offset:26624
  ds_read_b128 v[108:111], v45
  v_mfma_f32_32x32x16_bf16 v[112:127], v[48:51], v[64:67], v[112:127]
  v_mfma_f32_32x32x16_bf16 v[112:127], v[52:55], v[68:71], v[112:127]
  v_mfma_f32_32x32x16_bf16 v[112:127], v[56:59], v[72:75], v[112:127]
  v_mfma_f32_32x32x16_bf16 v[112:127], v[60:63], v[76:79], v[112:127]
  s_bitcmp1_b32 s2, 5
  s_cbranch_scc1 Lr_6
  s_add_u32 s54, s52, 32768
  buffer_load_dwordx4 v[144:147], v4, s[20:23], s54 offen offset:0 nt
  buffer_load_dwordx4 v[148:151], v5, s[20:23], s54 offen offset:1024 nt
  s_add_u32 s54, s52, 49152
  buffer_load_dwordx4 v[152:155], v4, s[20:23], s54 offen offset:0 nt
  buffer_load_dwordx4 v[156:159], v5, s[20:23], s54 offen offset:1024 nt
Lr_6:
  s_bitcmp1_b32 s2, 5
  s_cbranch_scc0 Lr_7
  s_add_u32 m0, s52, 98304
  s_add_u32 s54, s52, 147456
  buffer_load_dwordx4 v4, s[20:23], s54 offen offset:0 nt lds
  buffer_load_dwordx4 v5, s[20:23], s54 offen offset:1024 nt lds
Lr_7:
  v_lshrrev_b32 v28, 5, v0
  v_xor_b32 v28, v28, v2
  v_lshlrev_b32 v28, 4, v28
  v_and_b32 v29, 31, v0
  v_lshl_add_u32 v28, v29, 8, v28
  s_and_b32 s54, s48, 1
  s_lshl_b32 s54, s54, 13
  v_add_u32 v9, s54, v28
  v_xor_b32 v10, 32, v9
  v_xor_b32 v11, 64, v9
  v_xor_b32 v12, 96, v9
  v_xor_b32 v13, 128, v9
  v_xor_b32 v14, 160, v9
  v_xor_b32 v15, 192, v9
  v_xor_b32 v16, 224, v9
  s_lshl_b32 s54, s59, 12
  s_add_u32 s54, s54, 114688
  v_add_u32 v42, s54, v38
  v_add_u32 v43, s54, v39
  v_add_u32 v44, s54, v40
  v_add_u32 v45, s54, v41
  s_waitcnt vmcnt(8)
  s_bitcmp1_b32 s2, 5
  s_cbranch_scc0 Lr_8
  s_waitcnt vmcnt(4)
Lr_8:
  s_waitcnt lgkmcnt(0)
  s_barrier
  ds_read_b64_tr_b16 v[48:49], v37 offset:0
  ds_read_b64_tr_b16 v[50:51], v37 offset:2048
  ds_read_b128 v[64:67], v42
  ds_read_b64_tr_b16 v[52:53], v37 offset:8192
  ds_read_b64_tr_b16 v[54:55], v37 offset:10240
  ds_read_b128 v[68:71], v43
  ds_read_b64_tr_b16 v[56:57], v36 offset:49152
  ds_read_b64_tr_b16 v[58:59], v36 offset:51200
  ds_read_b128 v[72:75], v44
  ds_read_b64_tr_b16 v[60:61], v36 offset:57344
  ds_read_b64_tr_b16 v[62:63], v36 offset:59392
  ds_read_b128 v[76:79], v45
  v_mfma_f32_32x32x16_bf16 v[112:127], v[80:83], v[96:99], v[112:127]
  v_mfma_f32_32x32x16_bf16 v[112:127], v[84:87], v[100:103], v[112:127]
  v_mfma_f32_32x32x16_bf16 v[112:127], v[88:91], v[104:107], v[112:127]
  v_mfma_f32_32x32x16_bf16 v[112:127], v[92:95], v[108:111], v[112:127]
  s_waitcnt lgkmcnt(9)
  v_mfma_f32_32x32x16_bf16 v[112:127], v[48:51], v[64:67], v[112:127]
  s_waitcnt lgkmcnt(6)
  v_mfma_f32_32x32x16_bf16 v[112:127], v[52:55], v[68:71], v[112:127]
  s_waitcnt lgkmcnt(3)
  v_mfma_f32_32x32x16_bf16 v[112:127], v[56:59], v[72:75], v[112:127]
  s_waitcnt lgkmcnt(0)
  v_mfma_f32_32x32x16_bf16 v[112:127], v[60:63], v[76:79], v[112:127]
  v_and_b32 v28, 31, v0
  v_lshrrev_b32 v29, 5, v0
  v_lshlrev_b32 v28, 4, v28
  v_lshl_add_u32 v28, v29, 3, v28
  s_add_u32 s54, s52, 0
  v_add_u32 v28, s54, v28
  s_lshl_b32 s54, s99, 13
  s_add_u32 s54, s54, 0
  v_add_u32 v30, s54, v1
  s_nop 2
  v_cvt_pk_bf16_f32 v48, v112, v113
  v_cvt_pk_bf16_f32 v49, v114, v115
  ds_write_b64 v28, v[48:49] offset:0
  v_cvt_pk_bf16_f32 v50, v116, v117
  v_cvt_pk_bf16_f32 v51, v118, v119
  ds_write_b64 v28, v[50:51] offset:512
  v_cvt_pk_bf16_f32 v52, v120, v121
  v_cvt_pk_bf16_f32 v53, v122, v123
  ds_write_b64 v28, v[52:53] offset:1024
  v_cvt_pk_bf16_f32 v54, v124, v125
  v_cvt_pk_bf16_f32 v55, v126, v127
  ds_write_b64 v28, v[54:55] offset:1536
  s_bitcmp1_b32 s2, 5
  s_cbranch_scc1 Lr_9
  s_add_u32 s54, s52, 65536
  buffer_load_dwordx4 v[160:163], v4, s[20:23], s54 offen offset:0 nt
  buffer_load_dwordx4 v[164:167], v5, s[20:23], s54 offen offset:1024 nt
  s_add_u32 s54, s52, 81920
  buffer_load_dwordx4 v[168:171], v4, s[20:23], s54 offen offset:0 nt
  buffer_load_dwordx4 v[172:175], v5, s[20:23], s54 offen offset:1024 nt
  s_add_u32 s54, s52, 98304
  buffer_load_dwordx4 v[176:179], v4, s[20:23], s54 offen offset:0 nt
  buffer_load_dwordx4 v[180:183], v5, s[20:23], s54 offen offset:1024 nt
  s_add_u32 s54, s52, 114688
  buffer_load_dwordx4 v[184:187], v4, s[20:23], s54 offen offset:0 nt
  buffer_load_dwordx4 v[188:191], v5, s[20:23], s54 offen offset:1024 nt
Lr_9:
  s_waitcnt vmcnt(12)
  ds_write_b128 v35, v[128:131] offset:16384
  ds_write_b128 v35, v[132:135] offset:17408
  v_add_u32 v31, 0x10000, v35
  ds_write_b128 v31, v[136:139] offset:16384
  ds_write_b128 v31, v[140:143] offset:17408
  s_cmp_lt_u32 s98, 2
  s_mov_b32 s53, 0x14000
  s_cmov_b32 s53, 0x4000
  v_add_u32 v9, s53, v9
  v_add_u32 v10, s53, v10
  v_add_u32 v11, s53, v11
  v_add_u32 v12, s53, v12
  v_add_u32 v13, s53, v13
  v_add_u32 v14, s53, v14
  v_add_u32 v15, s53, v15
  v_add_u32 v16, s53, v16
  s_waitcnt lgkmcnt(0)
  s_barrier
  ds_read_b128 v[96:99], v30 offset:0
  ds_read_b128 v[100:103], v30 offset:1024
  ds_read_b128 v[104:107], v30 offset:2048
  ds_read_b128 v[108:111], v30 offset:3072
  ds_read_b128 v[112:115], v30 offset:4096
  ds_read_b128 v[116:119], v30 offset:5120
  ds_read_b128 v[120:123], v30 offset:6144
  ds_read_b128 v[124:127], v30 offset:7168
  ds_read_b128 v[64:67], v9
  ds_read_b128 v[68:71], v10
  ds_read_b128 v[72:75], v11
  ds_read_b128 v[76:79], v12
  ds_read_b128 v[80:83], v13
  ds_read_b128 v[84:87], v14
  ds_read_b128 v[88:91], v15
  ds_read_b128 v[92:95], v16
  s_mov_b32 s36, s12
  s_mov_b32 s37, s13
  s_mov_b32 s38, 4718592
  s_mov_b32 s39, 0x20000
  s_mov_b32 s40, s18
  s_mov_b32 s41, s19
  s_mov_b32 s42, 0x30000000
  s_mov_b32 s43, 0x20000
  s_mov_b32 s44, s16
  s_mov_b32 s45, s17
  s_mov_b32 s46, 256
  s_mov_b32 s47, 0x20000
  s_lshl_b32 s54, s49, 2
  s_add_u32 s54, s54, s51
  s_mul_i32 s58, s54, 73728
  s_add_u32 s58, s58, s65
  v_mov_b32 v32, 0x1000000
  v_mov_b32 v34, 0
  s_bitcmp1_b32 s2, 5
  s_cbranch_scc1 Lr_10
  s_add_u32 m0, s52, 32768
  s_add_u32 s54, s52, 131072
  buffer_load_dwordx4 v4, s[20:23], s54 offen offset:0 nt lds
  buffer_load_dwordx4 v5, s[20:23], s54 offen offset:1024 nt lds
  s_add_u32 m0, s52, 98304
  s_add_u32 s54, s52, 147456
  buffer_load_dwordx4 v4, s[20:23], s54 offen offset:0 nt lds
  buffer_load_dwordx4 v5, s[20:23], s54 offen offset:1024 nt lds
Lr_10:
  s_bitcmp1_b32 s2, 5
  s_cbranch_scc0 Lr_11
  s_add_u32 m0, s52, 65536
  s_add_u32 s54, s52, 163840
  buffer_load_dwordx4 v4, s[20:23], s54 offen offset:0 nt lds
  buffer_load_dwordx4 v5, s[20:23], s54 offen offset:1024 nt lds
Lr_11:
  s_waitcnt lgkmcnt(7)
  v_mfma_f32_32x32x16_bf16 v[128:143], v[64:67], v[96:99], 0
  s_waitcnt lgkmcnt(6)
  v_mfma_f32_32x32x16_bf16 v[128:143], v[68:71], v[100:103], v[128:143]
  s_waitcnt lgkmcnt(5)
  v_mfma_f32_32x32x16_bf16 v[128:143], v[72:75], v[104:107], v[128:143]
  s_waitcnt lgkmcnt(4)
  v_mfma_f32_32x32x16_bf16 v[128:143], v[76:79], v[108:111], v[128:143]
  s_waitcnt lgkmcnt(3)
  v_mfma_f32_32x32x16_bf16 v[128:143], v[80:83], v[112:115], v[128:143]
  s_waitcnt lgkmcnt(2)
  v_mfma_f32_32x32x16_bf16 v[128:143], v[84:87], v[116:119], v[128:143]
  s_waitcnt lgkmcnt(1)
  v_mfma_f32_32x32x16_bf16 v[128:143], v[88:91], v[120:123], v[128:143]
  s_waitcnt lgkmcnt(0)
  v_mfma_f32_32x32x16_bf16 v[128:143], v[92:95], v[124:127], v[128:143]
  s_xor_b32 s54, s48, 7
  s_or_b32 s54, s54, s2
  s_cmp_lg_u32 s54, 0
  s_cbranch_scc1 Llead_12
  s_mov_b64 exec, 1
  buffer_load_dword v33, v32, s[40:43], 0 offen sc1
  s_waitcnt vmcnt(0)
  v_add_u32 v33, 1, v33
  v_or_b32 v33, 0x80000000, v33
  buffer_store_dword v33, v34, s[44:47], 0 offen sc1
  buffer_store_dword v33, v32, s[40:43], 0 offen sc1
  s_mov_b64 exec, -1
Llead_12:
  s_waitcnt vmcnt(12)
  v_add_u32 v31, 0x10000, v35
  ds_write_b128 v31, v[144:147] offset:49152
  ds_write_b128 v31, v[148:151] offset:50176
  v_add_u32 v31, 0x20000, v35
  ds_write_b128 v31, v[152:155] offset:0
  ds_write_b128 v31, v[156:159] offset:1024
  s_cmp_lt_u32 s98, 2
  s_mov_b32 s53, 0xc000
  s_cmov_b32 s53, 0x18000
  v_add_u32 v9, s53, v9
  v_add_u32 v10, s53, v10
  v_add_u32 v11, s53, v11
  v_add_u32 v12, s53, v12
  v_add_u32 v13, s53, v13
  v_add_u32 v14, s53, v14
  v_add_u32 v15, s53, v15
  v_add_u32 v16, s53, v16
  s_waitcnt lgkmcnt(0)
  s_barrier
  ds_read_b128 v[64:67], v9
  ds_read_b128 v[68:71], v10
  ds_read_b128 v[72:75], v11
  ds_read_b128 v[76:79], v12
  ds_read_b128 v[80:83], v13
  ds_read_b128 v[84:87], v14
  ds_read_b128 v[88:91], v15
  ds_read_b128 v[92:95], v16
  s_bitcmp1_b32 s2, 5
  s_cbranch_scc1 Lr_13
  s_add_u32 m0, s52, 65536
  s_add_u32 s54, s52, 163840
  buffer_load_dwordx4 v4, s[20:23], s54 offen offset:0 nt lds
  buffer_load_dwordx4 v5, s[20:23], s54 offen offset:1024 nt lds
  s_add_u32 m0, s52, 81920
  s_add_u32 s54, s52, 180224
  buffer_load_dwordx4 v4, s[20:23], s54 offen offset:0 nt lds
  buffer_load_dwordx4 v5, s[20:23], s54 offen offset:1024 nt lds
Lr_13:
  s_bitcmp1_b32 s2, 5
  s_cbranch_scc0 Lr_14
  s_add_u32 m0, s52, 81920
  s_add_u32 s54, s52, 180224
  buffer_load_dwordx4 v4, s[20:23], s54 offen offset:0 nt lds
  buffer_load_dwordx4 v5, s[20:23], s54 offen offset:1024 nt lds
Lr_14:
  v_max3_f32 v25, v128, v129, v130
  v_max3_f32 v25, v25, v131, v132
  v_max3_f32 v25, v25, v133, v134
  v_max3_f32 v25, v25, v135, v136
  v_max3_f32 v25, v25, v137, v138
  v_max3_f32 v25, v25, v139, v140
  v_max3_f32 v25, v25, v141, v142
  v_max_f32 v25, v25, v143
  s_waitcnt lgkmcnt(7)
  v_mfma_f32_32x32x16_bf16 v[144:159], v[64:67], v[96:99], 0
  s_waitcnt lgkmcnt(6)
  v_mfma_f32_32x32x16_bf16 v[144:159], v[68:71], v[100:103], v[144:159]
  s_waitcnt lgkmcnt(5)
  v_mfma_f32_32x32x16_bf16 v[144:159], v[72:75], v[104:107], v[144:159]
  s_waitcnt lgkmcnt(4)
  v_mfma_f32_32x32x16_bf16 v[144:159], v[76:79], v[108:111], v[144:159]
  s_waitcnt lgkmcnt(3)
  v_mfma_f32_32x32x16_bf16 v[144:159], v[80:83], v[112:115], v[144:159]
  s_waitcnt lgkmcnt(2)
  v_mfma_f32_32x32x16_bf16 v[144:159], v[84:87], v[116:119], v[144:159]
  s_waitcnt lgkmcnt(1)
  v_mfma_f32_32x32x16_bf16 v[144:159], v[88:91], v[120:123], v[144:159]
  s_waitcnt lgkmcnt(0)
  v_mfma_f32_32x32x16_bf16 v[144:159], v[92:95], v[124:127], v[144:159]
  s_mov_b32 s60, 0x3e0293ee
  s_mov_b32 s61, s60
  s_xor_b32 s54, s51, 1
  s_lshl_b32 s54, s54, 7
  s_lshl_b32 s64, s48, 12
  s_add_u32 s64, s64, s54
  v_lshrrev_b32 v28, 3, v0
  v_and_b32 v29, 1, v3
  v_lshlrev_b32 v29, 2, v29
  v_and_b32 v30, 7, v0
  v_xor_b32 v29, v29, v30
  v_lshlrev_b32 v29, 4, v29
  v_lshl_add_u32 v6, v28, 8, v29
  v_lshrrev_b32 v28, 5, v0
  v_lshrrev_b32 v29, 2, v2
  v_lshl_add_u32 v28, v28, 2, v29
  v_and_b32 v29, 2, v29
  v_and_b32 v30, 1, v3
  v_or_b32 v29, v29, v30
  v_xor_b32 v29, s98, v29
  v_lshlrev_b32 v29, 5, v29
  v_lshl_add_u32 v29, v28, 7, v29
  v_and_b32 v30, 3, v2
  v_lshl_add_u32 v29, v30, 3, v29
  s_lshl_b32 s54, s98, 12
  v_add_u32 v7, s54, v29
  v_xor_b32 v8, 64, v7
  v_lshrrev_b32 v28, 5, v0
  v_lshlrev_b32 v28, 3, v28
  v_lshrrev_b32 v29, 2, v0
  v_add_u32 v28, v28, v29
  s_movk_i32 s54, 1152
  v_mul_lo_u32 v28, v28, s54
  v_lshl_add_u32 v28, v30, 3, v28
  s_lshl_b32 s54, s48, 7
  s_add_u32 s54, s54, 114688
  v_add_u32 v17, s54, v28
  s_lshr_b32 s54, s48, 1
  s_lshl_b32 s54, s54, 5
  s_add_u32 s54, s54, 115712
  v_add_u32 v18, s54, v28
  v_and_b32 v28, 31, v0
  s_lshl_b32 s54, s99, 9
  s_add_u32 s54, s54, 155648
  v_lshlrev_b32 v28, 4, v28
  v_add_u32 v19, s54, v28
  s_lshl_b32 s54, s98, 2
  v_add_u32 v20, s54, v19
  s_add_u32 s54, s52, 65536
  v_add_u32 v27, s54, v1
  v_lshlrev_b32 v29, 9, v3
  v_lshl_add_u32 v21, v2, 4, v29
  s_waitcnt vmcnt(12)
  ds_write_b128 v35, v[160:163] offset:0
  ds_write_b128 v35, v[164:167] offset:1024
  ds_write_b128 v35, v[168:171] offset:16384
  ds_write_b128 v35, v[172:175] offset:17408
  s_cmp_lt_u32 s98, 2
  s_mov_b32 s53, 0xfffe4000
  s_cmov_b32 s53, 0xfffe4000
  v_add_u32 v9, s53, v9
  v_add_u32 v10, s53, v10
  v_add_u32 v11, s53, v11
  v_add_u32 v12, s53, v12
  v_add_u32 v13, s53, v13
  v_add_u32 v14, s53, v14
  v_add_u32 v15, s53, v15
  v_add_u32 v16, s53, v16
  s_waitcnt lgkmcnt(0)
  s_barrier
  ds_read_b128 v[64:67], v9
  ds_read_b128 v[68:71], v10
  ds_read_b128 v[72:75], v11
  ds_read_b128 v[76:79], v12
  ds_read_b128 v[80:83], v13
  ds_read_b128 v[84:87], v14
  ds_read_b128 v[88:91], v15
  ds_read_b128 v[92:95], v16
  s_add_u32 m0, s52, 49152
  s_add_u32 s54, s52, 196608
  buffer_load_dwordx4 v4, s[20:23], s54 offen offset:0 nt lds
  buffer_load_dwordx4 v5, s[20:23], s54 offen offset:1024 nt lds
  v_max3_f32 v25, v25, v144, v145
  v_max3_f32 v25, v25, v146, v147
  v_max3_f32 v25, v25, v148, v149
  v_max3_f32 v25, v25, v150, v151
  v_max3_f32 v25, v25, v152, v153
  v_max3_f32 v25, v25, v154, v155
  v_max3_f32 v25, v25, v156, v157
  v_max3_f32 v25, v25, v158, v159
  s_waitcnt lgkmcnt(7)
  v_mfma_f32_32x32x16_bf16 v[160:175], v[64:67], v[96:99], 0
  s_waitcnt lgkmcnt(6)
  v_mfma_f32_32x32x16_bf16 v[160:175], v[68:71], v[100:103], v[160:175]
  s_waitcnt lgkmcnt(5)
  v_mfma_f32_32x32x16_bf16 v[160:175], v[72:75], v[104:107], v[160:175]
  s_waitcnt lgkmcnt(4)
  v_mfma_f32_32x32x16_bf16 v[160:175], v[76:79], v[108:111], v[160:175]
  s_waitcnt lgkmcnt(3)
  v_mfma_f32_32x32x16_bf16 v[160:175], v[80:83], v[112:115], v[160:175]
  s_waitcnt lgkmcnt(2)
  v_mfma_f32_32x32x16_bf16 v[160:175], v[84:87], v[116:119], v[160:175]
  s_waitcnt lgkmcnt(1)
  v_mfma_f32_32x32x16_bf16 v[160:175], v[88:91], v[120:123], v[160:175]
  s_waitcnt lgkmcnt(0)
  v_mfma_f32_32x32x16_bf16 v[160:175], v[92:95], v[124:127], v[160:175]
  s_waitcnt vmcnt(10)
  v_add_u32 v31, 0x10000, v35
  ds_write_b128 v31, v[176:179] offset:49152
  ds_write_b128 v31, v[180:183] offset:50176
  v_add_u32 v31, 0x20000, v35
  ds_write_b128 v31, v[184:187] offset:0
  ds_write_b128 v31, v[188:191] offset:1024
  s_cmp_lt_u32 s98, 2
  s_mov_b32 s53, 0x1c000
  s_cmov_b32 s53, 0x1c000
  v_add_u32 v9, s53, v9
  v_add_u32 v10, s53, v10
  v_add_u32 v11, s53, v11
  v_add_u32 v12, s53, v12
  v_add_u32 v13, s53, v13
  v_add_u32 v14, s53, v14
  v_add_u32 v15, s53, v15
  v_add_u32 v16, s53, v16
  s_waitcnt lgkmcnt(0)
  s_barrier
  ds_read_b128 v[64:67], v9
  ds_read_b128 v[68:71], v10
  ds_read_b128 v[72:75], v11
  ds_read_b128 v[76:79], v12
  ds_read_b128 v[80:83], v13
  ds_read_b128 v[84:87], v14
  ds_read_b128 v[88:91], v15
  ds_read_b128 v[92:95], v16
  s_bitcmp1_b32 s2, 5
  s_cbranch_scc1 Lr_15
  s_add_u32 m0, s52, 16384
  s_add_u32 s54, s52, 212992
  buffer_load_dwordx4 v4, s[20:23], s54 offen offset:0 nt lds
  buffer_load_dwordx4 v5, s[20:23], s54 offen offset:1024 nt lds
  s_add_u32 m0, s52, 0
  s_add_u32 s54, s52, 229376
  buffer_load_dwordx4 v4, s[20:23], s54 offen offset:0 nt lds
  buffer_load_dwordx4 v5, s[20:23], s54 offen offset:1024 nt lds
Lr_15:
  s_bitcmp1_b32 s2, 5
  s_cbranch_scc0 Lr_16
  s_add_u32 m0, s52, 16384
  s_add_u32 s54, s52, 212992
  buffer_load_dwordx4 v4, s[20:23], s54 offen offset:0 nt lds
  buffer_load_dwordx4 v5, s[20:23], s54 offen offset:1024 nt lds
Lr_16:
  v_max3_f32 v25, v25, v160, v161
  v_max3_f32 v25, v25, v162, v163
  v_max3_f32 v25, v25, v164, v165
  v_max3_f32 v25, v25, v166, v167
  v_max3_f32 v25, v25, v168, v169
  v_max3_f32 v25, v25, v170, v171
  v_max3_f32 v25, v25, v172, v173
  v_max3_f32 v25, v25, v174, v175
  s_waitcnt lgkmcnt(7)
  v_mfma_f32_32x32x16_bf16 v[176:191], v[64:67], v[96:99], 0
  s_waitcnt lgkmcnt(6)
  v_mfma_f32_32x32x16_bf16 v[176:191], v[68:71], v[100:103], v[176:191]
  s_waitcnt lgkmcnt(5)
  v_mfma_f32_32x32x16_bf16 v[176:191], v[72:75], v[104:107], v[176:191]
  s_waitcnt lgkmcnt(4)
  v_mfma_f32_32x32x16_bf16 v[176:191], v[76:79], v[108:111], v[176:191]
  s_waitcnt lgkmcnt(3)
  v_mfma_f32_32x32x16_bf16 v[176:191], v[80:83], v[112:115], v[176:191]
  s_waitcnt lgkmcnt(2)
  v_mfma_f32_32x32x16_bf16 v[176:191], v[84:87], v[116:119], v[176:191]
  s_waitcnt lgkmcnt(1)
  v_mfma_f32_32x32x16_bf16 v[176:191], v[88:91], v[120:123], v[176:191]
  s_waitcnt lgkmcnt(0)
  v_mfma_f32_32x32x16_bf16 v[176:191], v[92:95], v[124:127], v[176:191]
  s_cmp_lt_u32 s98, 2
  s_mov_b32 s53, 0xffff8000
  s_cmov_b32 s53, 0xfffec000
  v_add_u32 v9, s53, v9
  v_add_u32 v10, s53, v10
  v_add_u32 v11, s53, v11
  v_add_u32 v12, s53, v12
  v_add_u32 v13, s53, v13
  v_add_u32 v14, s53, v14
  v_add_u32 v15, s53, v15
  v_add_u32 v16, s53, v16
  s_waitcnt vmcnt(10)
  s_bitcmp1_b32 s2, 5
  s_cbranch_scc0 Lr_17
  s_waitcnt vmcnt(8)
Lr_17:
  s_barrier
  ds_read_b128 v[64:67], v9
  ds_read_b128 v[68:71], v10
  ds_read_b128 v[72:75], v11
  ds_read_b128 v[76:79], v12
  ds_read_b128 v[80:83], v13
  ds_read_b128 v[84:87], v14
  ds_read_b128 v[88:91], v15
  ds_read_b128 v[92:95], v16
  s_add_u32 m0, s65, 114688
  s_add_u32 s54, s58, 0
  buffer_load_dwordx4 v1, s[36:39], s54 offen lds
  s_add_u32 m0, s65, 122880
  s_add_u32 s54, s58, 8192
  buffer_load_dwordx4 v1, s[36:39], s54 offen lds
  s_add_u32 m0, s65, 131072
  s_add_u32 s54, s58, 16384
  buffer_load_dwordx4 v1, s[36:39], s54 offen lds
  s_bitcmp1_b32 s2, 5
  s_cbranch_scc0 Lr_18
  s_add_u32 m0, s52, 0
  s_add_u32 s54, s52, 229376
  buffer_load_dwordx4 v4, s[20:23], s54 offen offset:0 nt lds
  buffer_load_dwordx4 v5, s[20:23], s54 offen offset:1024 nt lds
Lr_18:
  v_max3_f32 v25, v25, v176, v177
  v_max3_f32 v25, v25, v178, v179
  v_max3_f32 v25, v25, v180, v181
  v_max3_f32 v25, v25, v182, v183
  v_max3_f32 v25, v25, v184, v185
  v_max3_f32 v25, v25, v186, v187
  v_max3_f32 v25, v25, v188, v189
  v_max3_f32 v25, v25, v190, v191
  s_waitcnt lgkmcnt(7)
  v_mfma_f32_32x32x16_bf16 v[192:207], v[64:67], v[96:99], 0
  s_waitcnt lgkmcnt(6)
  v_mfma_f32_32x32x16_bf16 v[192:207], v[68:71], v[100:103], v[192:207]
  s_waitcnt lgkmcnt(5)
  v_mfma_f32_32x32x16_bf16 v[192:207], v[72:75], v[104:107], v[192:207]
  s_waitcnt lgkmcnt(4)
  v_mfma_f32_32x32x16_bf16 v[192:207], v[76:79], v[108:111], v[192:207]
  s_waitcnt lgkmcnt(3)
  v_mfma_f32_32x32x16_bf16 v[192:207], v[80:83], v[112:115], v[192:207]
  s_waitcnt lgkmcnt(2)
  v_mfma_f32_32x32x16_bf16 v[192:207], v[84:87], v[116:119], v[192:207]
  s_waitcnt lgkmcnt(1)
  v_mfma_f32_32x32x16_bf16 v[192:207], v[88:91], v[120:123], v[192:207]
  s_waitcnt lgkmcnt(0)
  v_mfma_f32_32x32x16_bf16 v[192:207], v[92:95], v[124:127], v[192:207]
  s_cmp_lt_u32 s98, 2
  s_mov_b32 s53, 0xffffc000
  s_cmov_b32 s53, 0x8000
  v_add_u32 v9, s53, v9
  v_add_u32 v10, s53, v10
  v_add_u32 v11, s53, v11
  v_add_u32 v12, s53, v12
  v_add_u32 v13, s53, v13
  v_add_u32 v14, s53, v14
  v_add_u32 v15, s53, v15
  v_add_u32 v16, s53, v16
  s_waitcnt vmcnt(9)
  s_barrier
  ds_read_b128 v[64:67], v9
  ds_read_b128 v[68:71], v10
  ds_read_b128 v[72:75], v11
  ds_read_b128 v[76:79], v12
  ds_read_b128 v[80:83], v13
  ds_read_b128 v[84:87], v14
  ds_read_b128 v[88:91], v15
  ds_read_b128 v[92:95], v16
  s_add_u32 m0, s65, 139264
  s_add_u32 s54, s58, 24576
  buffer_load_dwordx4 v1, s[36:39], s54 offen lds
  s_add_u32 m0, s65, 147456
  s_add_u32 s54, s58, 32768
  buffer_load_dwordx4 v1, s[36:39], s54 offen lds
  s_add_u32 m0, s52, 98304
  s_add_u32 s54, s52, 245760
  buffer_load_dwordx4 v4, s[20:23], s54 offen offset:0 nt lds
  buffer_load_dwordx4 v5, s[20:23], s54 offen offset:1024 nt lds
  v_max3_f32 v25, v25, v192, v193
  v_max3_f32 v25, v25, v194, v195
  v_max3_f32 v25, v25, v196, v197
  v_max3_f32 v25, v25, v198, v199
  v_max3_f32 v25, v25, v200, v201
  v_max3_f32 v25, v25, v202, v203
  v_max3_f32 v25, v25, v204, v205
  v_max3_f32 v25, v25, v206, v207
  s_waitcnt lgkmcnt(7)
  v_mfma_f32_32x32x16_bf16 v[208:223], v[64:67], v[96:99], 0
  s_waitcnt lgkmcnt(6)
  v_mfma_f32_32x32x16_bf16 v[208:223], v[68:71], v[100:103], v[208:223]
  s_waitcnt lgkmcnt(5)
  v_mfma_f32_32x32x16_bf16 v[208:223], v[72:75], v[104:107], v[208:223]
  s_waitcnt lgkmcnt(4)
  v_mfma_f32_32x32x16_bf16 v[208:223], v[76:79], v[108:111], v[208:223]
  s_waitcnt lgkmcnt(3)
  v_mfma_f32_32x32x16_bf16 v[208:223], v[80:83], v[112:115], v[208:223]
  s_waitcnt lgkmcnt(2)
  v_mfma_f32_32x32x16_bf16 v[208:223], v[84:87], v[116:119], v[208:223]
  s_waitcnt lgkmcnt(1)
  v_mfma_f32_32x32x16_bf16 v[208:223], v[88:91], v[120:123], v[208:223]
  s_waitcnt lgkmcnt(0)
  v_mfma_f32_32x32x16_bf16 v[208:223], v[92:95], v[124:127], v[208:223]
  s_cmp_lt_u32 s98, 2
  s_mov_b32 s53, 0xffff0000
  s_cmov_b32 s53, 0xffffc000
  v_add_u32 v9, s53, v9
  v_add_u32 v10, s53, v10
  v_add_u32 v11, s53, v11
  v_add_u32 v12, s53, v12
  v_add_u32 v13, s53, v13
  v_add_u32 v14, s53, v14
  v_add_u32 v15, s53, v15
  v_add_u32 v16, s53, v16
  s_waitcnt vmcnt(9)
  s_barrier
  ds_read_b128 v[64:67], v9
  ds_read_b128 v[68:71], v10
  ds_read_b128 v[72:75], v11
  ds_read_b128 v[76:79], v12
  ds_read_b128 v[80:83], v13
  ds_read_b128 v[84:87], v14
  ds_read_b128 v[88:91], v15
  ds_read_b128 v[92:95], v16
  s_add_u32 m0, s52, 32768
  s_add_u32 s54, s64, 0
  buffer_load_dwordx4 v6, s[24:27], s54 offen nt lds
  s_add_u32 s54, s54, 1024
  buffer_load_dwordx4 v6, s[24:27], s54 offen offset:1024 nt lds
  v_max3_f32 v25, v25, v208, v209
  v_max3_f32 v25, v25, v210, v211
  v_max3_f32 v25, v25, v212, v213
  v_max3_f32 v25, v25, v214, v215
  v_max3_f32 v25, v25, v216, v217
  v_max3_f32 v25, v25, v218, v219
  v_max3_f32 v25, v25, v220, v221
  v_max3_f32 v25, v25, v222, v223
  s_waitcnt lgkmcnt(7)
  v_mfma_f32_32x32x16_bf16 v[224:239], v[64:67], v[96:99], 0
  s_waitcnt lgkmcnt(6)
  v_mfma_f32_32x32x16_bf16 v[224:239], v[68:71], v[100:103], v[224:239]
  s_waitcnt lgkmcnt(5)
  v_mfma_f32_32x32x16_bf16 v[224:239], v[72:75], v[104:107], v[224:239]
  s_waitcnt lgkmcnt(4)
  v_mfma_f32_32x32x16_bf16 v[224:239], v[76:79], v[108:111], v[224:239]
  s_waitcnt lgkmcnt(3)
  v_mfma_f32_32x32x16_bf16 v[224:239], v[80:83], v[112:115], v[224:239]
  s_waitcnt lgkmcnt(2)
  v_mfma_f32_32x32x16_bf16 v[224:239], v[84:87], v[116:119], v[224:239]
  s_waitcnt lgkmcnt(1)
  v_mfma_f32_32x32x16_bf16 v[224:239], v[88:91], v[120:123], v[224:239]
  s_waitcnt lgkmcnt(0)
  v_mfma_f32_32x32x16_bf16 v[224:239], v[92:95], v[124:127], v[224:239]
  buffer_load_dword v33, v34, s[44:47], 0 offen
  s_cmp_lt_u32 s98, 2
  s_mov_b32 s53, 0x14000
  s_cmov_b32 s53, 0xffff4000
  v_add_u32 v9, s53, v9
  v_add_u32 v10, s53, v10
  v_add_u32 v11, s53, v11
  v_add_u32 v12, s53, v12
  v_add_u32 v13, s53, v13
  v_add_u32 v14, s53, v14
  v_add_u32 v15, s53, v15
  v_add_u32 v16, s53, v16
  s_waitcnt vmcnt(3)
  s_barrier
  ds_read_b128 v[64:67], v9
  ds_read_b128 v[68:71], v10
  ds_read_b128 v[72:75], v11
  ds_read_b128 v[76:79], v12
  ds_read_b128 v[80:83], v13
  ds_read_b128 v[84:87], v14
  ds_read_b128 v[88:91], v15
  ds_read_b128 v[92:95], v16
  s_bitcmp1_b32 s2, 5
  s_cbranch_scc1 Lr_19
  s_add_u32 m0, s52, 16384
  s_add_u32 s54, s64, 32768
  buffer_load_dwordx4 v6, s[24:27], s54 offen nt lds
  s_add_u32 s54, s54, 1024
  buffer_load_dwordx4 v6, s[24:27], s54 offen offset:1024 nt lds
  s_add_u32 m0, s52, 49152
  s_add_u32 s54, s64, 65536
  buffer_load_dwordx4 v6, s[24:27], s54 offen nt lds
  s_add_u32 s54, s54, 1024
  buffer_load_dwordx4 v6, s[24:27], s54 offen offset:1024 nt lds
Lr_19:
  s_bitcmp1_b32 s2, 5
  s_cbranch_scc0 Lr_20
  s_add_u32 m0, s52, 16384
  s_add_u32 s54, s64, 32768
  buffer_load_dwordx4 v6, s[24:27], s54 offen nt lds
  s_add_u32 s54, s54, 1024
  buffer_load_dwordx4 v6, s[24:27], s54 offen offset:1024 nt lds
Lr_20:
  ds_read_b64_tr_b16 v[44:45], v17 offset:0
  ds_read_b64_tr_b16 v[46:47], v17 offset:9216
  ds_read_b64_tr_b16 v[48:49], v17 offset:32
  ds_read_b64_tr_b16 v[50:51], v17 offset:9248
  ds_read_b64_tr_b16 v[52:53], v17 offset:64
  ds_read_b64_tr_b16 v[54:55], v17 offset:9280
  ds_read_b64_tr_b16 v[56:57], v17 offset:96
  ds_read_b64_tr_b16 v[58:59], v17 offset:9312
  ds_read_b64_tr_b16 v[60:61], v18 offset:0
  ds_read_b64_tr_b16 v[62:63], v18 offset:9216
  v_max3_f32 v25, v25, v224, v225
  v_max3_f32 v25, v25, v226, v227
  v_max3_f32 v25, v25, v228, v229
  v_max3_f32 v25, v25, v230, v231
  v_max3_f32 v25, v25, v232, v233
  v_max3_f32 v25, v25, v234, v235
  v_max3_f32 v25, v25, v236, v237
  v_max3_f32 v25, v25, v238, v239
  s_waitcnt lgkmcnt(15)
  v_mfma_f32_32x32x16_bf16 v[240:255], v[64:67], v[96:99], 0
  v_mfma_f32_32x32x16_bf16 v[240:255], v[68:71], v[100:103], v[240:255]
  v_mfma_f32_32x32x16_bf16 v[240:255], v[72:75], v[104:107], v[240:255]
  s_waitcnt lgkmcnt(14)
  v_mfma_f32_32x32x16_bf16 v[240:255], v[76:79], v[108:111], v[240:255]
  s_waitcnt lgkmcnt(13)
  v_mfma_f32_32x32x16_bf16 v[240:255], v[80:83], v[112:115], v[240:255]
  s_waitcnt lgkmcnt(12)
  v_mfma_f32_32x32x16_bf16 v[240:255], v[84:87], v[116:119], v[240:255]
  s_waitcnt lgkmcnt(11)
  v_mfma_f32_32x32x16_bf16 v[240:255], v[88:91], v[120:123], v[240:255]
  s_waitcnt lgkmcnt(10)
  v_mfma_f32_32x32x16_bf16 v[240:255], v[92:95], v[124:127], v[240:255]
  s_nop 11
  v_max3_f32 v25, v25, v240, v241
  v_max3_f32 v25, v25, v242, v243
  v_max3_f32 v25, v25, v244, v245
  v_max3_f32 v25, v25, v246, v247
  v_max3_f32 v25, v25, v248, v249
  v_max3_f32 v25, v25, v250, v251
  v_max3_f32 v25, v25, v252, v253
  v_max3_f32 v25, v25, v254, v255
  v_mov_b32 v28, v25
  s_nop 1
  v_permlane32_swap_b32 v25, v28
  v_max_f32 v25, v25, v28
  ds_write_b32 v20, v25
  s_waitcnt lgkmcnt(0)
  s_barrier
  ds_read_b128 v[28:31], v19
  s_add_u32 m0, s65, 114688
  s_add_u32 s54, s58, 36864
  buffer_load_dwordx4 v1, s[36:39], s54 offen lds
  s_add_u32 m0, s65, 122880
  s_add_u32 s54, s58, 45056
  buffer_load_dwordx4 v1, s[36:39], s54 offen lds
  s_bitcmp1_b32 s2, 5
  s_cbranch_scc0 Lr_21
  s_add_u32 m0, s52, 49152
  s_add_u32 s54, s64, 65536
  buffer_load_dwordx4 v6, s[24:27], s54 offen nt lds
  s_add_u32 s54, s54, 1024
  buffer_load_dwordx4 v6, s[24:27], s54 offen offset:1024 nt lds
Lr_21:
  s_waitcnt lgkmcnt(0)
  v_max3_f32 v25, v28, v29, v30
  v_max_f32 v25, v25, v31
  v_mul_f32 v24, s60, v25
  v_sub_f32 v24, 0, v24
  v_pk_fma_f32 v[128:129], v[128:129], s[60:61], v[24:25] op_sel_hi:[1,0,0]
  v_pk_fma_f32 v[130:131], v[130:131], s[60:61], v[24:25] op_sel_hi:[1,0,0]
  v_pk_fma_f32 v[132:133], v[132:133], s[60:61], v[24:25] op_sel_hi:[1,0,0]
  v_pk_fma_f32 v[134:135], v[134:135], s[60:61], v[24:25] op_sel_hi:[1,0,0]
  v_pk_fma_f32 v[136:137], v[136:137], s[60:61], v[24:25] op_sel_hi:[1,0,0]
  v_pk_fma_f32 v[138:139], v[138:139], s[60:61], v[24:25] op_sel_hi:[1,0,0]
  v_pk_fma_f32 v[140:141], v[140:141], s[60:61], v[24:25] op_sel_hi:[1,0,0]
  v_pk_fma_f32 v[142:143], v[142:143], s[60:61], v[24:25] op_sel_hi:[1,0,0]
  v_exp_f32 v128, v128
  v_exp_f32 v129, v129
  v_exp_f32 v130, v130
  v_exp_f32 v131, v131
  v_exp_f32 v132, v132
  v_exp_f32 v133, v133
  v_exp_f32 v134, v134
  v_exp_f32 v135, v135
  v_exp_f32 v136, v136
  v_exp_f32 v137, v137
  v_exp_f32 v138, v138
  v_exp_f32 v139, v139
  v_exp_f32 v140, v140
  v_exp_f32 v141, v141
  v_exp_f32 v142, v142
  v_exp_f32 v143, v143
  v_pk_add_f32 v[22:23], v[128:129], v[130:131]
  v_pk_add_f32 v[22:23], v[22:23], v[132:133]
  v_pk_add_f32 v[22:23], v[22:23], v[134:135]
  v_pk_add_f32 v[22:23], v[22:23], v[136:137]
  v_pk_add_f32 v[22:23], v[22:23], v[138:139]
  v_pk_add_f32 v[22:23], v[22:23], v[140:141]
  v_pk_add_f32 v[22:23], v[22:23], v[142:143]
  v_cvt_pk_bf16_f32 v128, v128, v129
  v_cvt_pk_bf16_f32 v129, v130, v131
  v_cvt_pk_bf16_f32 v130, v132, v133
  v_cvt_pk_bf16_f32 v131, v134, v135
  v_cvt_pk_bf16_f32 v132, v136, v137
  v_cvt_pk_bf16_f32 v133, v138, v139
  v_cvt_pk_bf16_f32 v134, v140, v141
  v_cvt_pk_bf16_f32 v135, v142, v143
  s_waitcnt vmcnt(7)
  s_barrier
  ds_read_b64_tr_b16 v[64:65], v7 offset:32768
  ds_read_b64_tr_b16 v[66:67], v7 offset:33792
  ds_read_b64_tr_b16 v[68:69], v8 offset:32768
  ds_read_b64_tr_b16 v[70:71], v8 offset:33792
  ds_read_b64_tr_b16 v[72:73], v7 offset:34816
  ds_read_b64_tr_b16 v[74:75], v7 offset:35840
  ds_read_b64_tr_b16 v[76:77], v8 offset:34816
  ds_read_b64_tr_b16 v[78:79], v8 offset:35840
  s_add_u32 m0, s65, 131072
  s_add_u32 s54, s58, 53248
  buffer_load_dwordx4 v1, s[36:39], s54 offen lds
  s_add_u32 m0, s65, 139264
  s_add_u32 s54, s58, 61440
  buffer_load_dwordx4 v1, s[36:39], s54 offen lds
  s_add_u32 m0, s52, 0
  s_add_u32 s54, s64, 98304
  buffer_load_dwordx4 v6, s[24:27], s54 offen nt lds
  s_add_u32 s54, s54, 1024
  buffer_load_dwordx4 v6, s[24:27], s54 offen offset:1024 nt lds
  v_pk_fma_f32 v[144:145], v[144:145], s[60:61], v[24:25] op_sel_hi:[1,0,0]
  v_pk_fma_f32 v[146:147], v[146:147], s[60:61], v[24:25] op_sel_hi:[1,0,0]
  v_pk_fma_f32 v[148:149], v[148:149], s[60:61], v[24:25] op_sel_hi:[1,0,0]
  v_pk_fma_f32 v[150:151], v[150:151], s[60:61], v[24:25] op_sel_hi:[1,0,0]
  v_pk_fma_f32 v[152:153], v[152:153], s[60:61], v[24:25] op_sel_hi:[1,0,0]
  v_pk_fma_f32 v[154:155], v[154:155], s[60:61], v[24:25] op_sel_hi:[1,0,0]
  v_pk_fma_f32 v[156:157], v[156:157], s[60:61], v[24:25] op_sel_hi:[1,0,0]
  v_pk_fma_f32 v[158:159], v[158:159], s[60:61], v[24:25] op_sel_hi:[1,0,0]
  v_exp_f32 v144, v144
  v_exp_f32 v145, v145
  s_waitcnt lgkmcnt(6)
  v_mfma_f32_32x32x16_bf16 v[96:111], v[64:67], v[128:131], 0
  v_exp_f32 v146, v146
  v_exp_f32 v147, v147
  v_exp_f32 v148, v148
  v_exp_f32 v149, v149
  v_exp_f32 v150, v150
  v_exp_f32 v151, v151
  v_exp_f32 v152, v152
  v_exp_f32 v153, v153
  v_exp_f32 v154, v154
  v_exp_f32 v155, v155
  s_waitcnt lgkmcnt(4)
  v_mfma_f32_32x32x16_bf16 v[112:127], v[68:71], v[128:131], 0
  v_exp_f32 v156, v156
  v_exp_f32 v157, v157
  v_exp_f32 v158, v158
  v_exp_f32 v159, v159
  v_pk_add_f32 v[22:23], v[22:23], v[144:145]
  v_pk_add_f32 v[22:23], v[22:23], v[146:147]
  v_pk_add_f32 v[22:23], v[22:23], v[148:149]
  v_pk_add_f32 v[22:23], v[22:23], v[150:151]
  v_pk_add_f32 v[22:23], v[22:23], v[152:153]
  v_pk_add_f32 v[22:23], v[22:23], v[154:155]
  s_waitcnt lgkmcnt(2)
  v_mfma_f32_32x32x16_bf16 v[96:111], v[72:75], v[132:135], v[96:111]
  v_pk_add_f32 v[22:23], v[22:23], v[156:157]
  v_pk_add_f32 v[22:23], v[22:23], v[158:159]
  v_cvt_pk_bf16_f32 v144, v144, v145
  v_cvt_pk_bf16_f32 v145, v146, v147
  v_cvt_pk_bf16_f32 v146, v148, v149
  v_cvt_pk_bf16_f32 v147, v150, v151
  v_cvt_pk_bf16_f32 v148, v152, v153
  v_cvt_pk_bf16_f32 v149, v154, v155
  v_cvt_pk_bf16_f32 v150, v156, v157
  v_cvt_pk_bf16_f32 v151, v158, v159
  s_waitcnt lgkmcnt(0)
  v_mfma_f32_32x32x16_bf16 v[112:127], v[76:79], v[132:135], v[112:127]
  s_waitcnt vmcnt(8)
  s_barrier
  ds_read_b64_tr_b16 v[64:65], v7 offset:16384
  ds_read_b64_tr_b16 v[66:67], v7 offset:17408
  ds_read_b64_tr_b16 v[68:69], v8 offset:16384
  ds_read_b64_tr_b16 v[70:71], v8 offset:17408
  ds_read_b64_tr_b16 v[72:73], v7 offset:18432
  ds_read_b64_tr_b16 v[74:75], v7 offset:19456
  ds_read_b64_tr_b16 v[76:77], v8 offset:18432
  ds_read_b64_tr_b16 v[78:79], v8 offset:19456
  s_add_u32 m0, s65, 147456
  s_add_u32 s54, s58, 69632
  buffer_load_dwordx4 v1, s[36:39], s54 offen lds
  s_add_u32 m0, s52, 32768
  s_add_u32 s54, s64, 131072
  buffer_load_dwordx4 v6, s[24:27], s54 offen nt lds
  s_add_u32 s54, s54, 1024
  buffer_load_dwordx4 v6, s[24:27], s54 offen offset:1024 nt lds
  v_pk_fma_f32 v[160:161], v[160:161], s[60:61], v[24:25] op_sel_hi:[1,0,0]
  v_pk_fma_f32 v[162:163], v[162:163], s[60:61], v[24:25] op_sel_hi:[1,0,0]
  v_pk_fma_f32 v[164:165], v[164:165], s[60:61], v[24:25] op_sel_hi:[1,0,0]
  v_pk_fma_f32 v[166:167], v[166:167], s[60:61], v[24:25] op_sel_hi:[1,0,0]
  v_pk_fma_f32 v[168:169], v[168:169], s[60:61], v[24:25] op_sel_hi:[1,0,0]
  v_pk_fma_f32 v[170:171], v[170:171], s[60:61], v[24:25] op_sel_hi:[1,0,0]
  v_pk_fma_f32 v[172:173], v[172:173], s[60:61], v[24:25] op_sel_hi:[1,0,0]
  v_pk_fma_f32 v[174:175], v[174:175], s[60:61], v[24:25] op_sel_hi:[1,0,0]
  v_exp_f32 v160, v160
  v_exp_f32 v161, v161
  s_waitcnt lgkmcnt(6)
  v_mfma_f32_32x32x16_bf16 v[96:111], v[64:67], v[144:147], v[96:111]
  v_exp_f32 v162, v162
  v_exp_f32 v163, v163
  v_exp_f32 v164, v164
  v_exp_f32 v165, v165
  v_exp_f32 v166, v166
  v_exp_f32 v167, v167
  v_exp_f32 v168, v168
  v_exp_f32 v169, v169
  v_exp_f32 v170, v170
  v_exp_f32 v171, v171
  s_waitcnt lgkmcnt(4)
  v_mfma_f32_32x32x16_bf16 v[112:127], v[68:71], v[144:147], v[112:127]
  v_exp_f32 v172, v172
  v_exp_f32 v173, v173
  v_exp_f32 v174, v174
  v_exp_f32 v175, v175
  v_pk_add_f32 v[22:23], v[22:23], v[160:161]
  v_pk_add_f32 v[22:23], v[22:23], v[162:163]
  v_pk_add_f32 v[22:23], v[22:23], v[164:165]
  v_pk_add_f32 v[22:23], v[22:23], v[166:167]
  v_pk_add_f32 v[22:23], v[22:23], v[168:169]
  v_pk_add_f32 v[22:23], v[22:23], v[170:171]
  s_waitcnt lgkmcnt(2)
  v_mfma_f32_32x32x16_bf16 v[96:111], v[72:75], v[148:151], v[96:111]
  v_pk_add_f32 v[22:23], v[22:23], v[172:173]
  v_pk_add_f32 v[22:23], v[22:23], v[174:175]
  v_cvt_pk_bf16_f32 v160, v160, v161
  v_cvt_pk_bf16_f32 v161, v162, v163
  v_cvt_pk_bf16_f32 v162, v164, v165
  v_cvt_pk_bf16_f32 v163, v166, v167
  v_cvt_pk_bf16_f32 v164, v168, v169
  v_cvt_pk_bf16_f32 v165, v170, v171
  v_cvt_pk_bf16_f32 v166, v172, v173
  v_cvt_pk_bf16_f32 v167, v174, v175
  s_waitcnt lgkmcnt(0)
  v_mfma_f32_32x32x16_bf16 v[112:127], v[76:79], v[148:151], v[112:127]
  s_waitcnt vmcnt(9)
  s_bitcmp1_b32 s2, 5
  s_cbranch_scc0 Lr_22
  s_waitcnt vmcnt(7)
Lr_22:
  s_barrier
  ds_read_b64_tr_b16 v[64:65], v7 offset:49152
  ds_read_b64_tr_b16 v[66:67], v7 offset:50176
  ds_read_b64_tr_b16 v[68:69], v8 offset:49152
  ds_read_b64_tr_b16 v[70:71], v8 offset:50176
  ds_read_b64_tr_b16 v[72:73], v7 offset:51200
  ds_read_b64_tr_b16 v[74:75], v7 offset:52224
  ds_read_b64_tr_b16 v[76:77], v8 offset:51200
  ds_read_b64_tr_b16 v[78:79], v8 offset:52224
  s_add_u32 m0, s52, 16384
  s_add_u32 s54, s64, 163840
  buffer_load_dwordx4 v6, s[24:27], s54 offen nt lds
  s_add_u32 s54, s54, 1024
  buffer_load_dwordx4 v6, s[24:27], s54 offen offset:1024 nt lds
  v_pk_fma_f32 v[176:177], v[176:177], s[60:61], v[24:25] op_sel_hi:[1,0,0]
  v_pk_fma_f32 v[178:179], v[178:179], s[60:61], v[24:25] op_sel_hi:[1,0,0]
  v_pk_fma_f32 v[180:181], v[180:181], s[60:61], v[24:25] op_sel_hi:[1,0,0]
  v_pk_fma_f32 v[182:183], v[182:183], s[60:61], v[24:25] op_sel_hi:[1,0,0]
  v_pk_fma_f32 v[184:185], v[184:185], s[60:61], v[24:25] op_sel_hi:[1,0,0]
  v_pk_fma_f32 v[186:187], v[186:187], s[60:61], v[24:25] op_sel_hi:[1,0,0]
  v_pk_fma_f32 v[188:189], v[188:189], s[60:61], v[24:25] op_sel_hi:[1,0,0]
  v_pk_fma_f32 v[190:191], v[190:191], s[60:61], v[24:25] op_sel_hi:[1,0,0]
  v_exp_f32 v176, v176
  v_exp_f32 v177, v177
  s_waitcnt lgkmcnt(6)
  v_mfma_f32_32x32x16_bf16 v[96:111], v[64:67], v[160:163], v[96:111]
  v_exp_f32 v178, v178
  v_exp_f32 v179, v179
  v_exp_f32 v180, v180
  v_exp_f32 v181, v181
  v_exp_f32 v182, v182
  v_exp_f32 v183, v183
  v_exp_f32 v184, v184
  v_exp_f32 v185, v185
  v_exp_f32 v186, v186
  v_exp_f32 v187, v187
  s_waitcnt lgkmcnt(4)
  v_mfma_f32_32x32x16_bf16 v[112:127], v[68:71], v[160:163], v[112:127]
  v_exp_f32 v188, v188
  v_exp_f32 v189, v189
  v_exp_f32 v190, v190
  v_exp_f32 v191, v191
  v_pk_add_f32 v[22:23], v[22:23], v[176:177]
  v_pk_add_f32 v[22:23], v[22:23], v[178:179]
  v_pk_add_f32 v[22:23], v[22:23], v[180:181]
  v_pk_add_f32 v[22:23], v[22:23], v[182:183]
  v_pk_add_f32 v[22:23], v[22:23], v[184:185]
  v_pk_add_f32 v[22:23], v[22:23], v[186:187]
  s_waitcnt lgkmcnt(2)
  v_mfma_f32_32x32x16_bf16 v[96:111], v[72:75], v[164:167], v[96:111]
  v_pk_add_f32 v[22:23], v[22:23], v[188:189]
  v_pk_add_f32 v[22:23], v[22:23], v[190:191]
  v_cvt_pk_bf16_f32 v176, v176, v177
  v_cvt_pk_bf16_f32 v177, v178, v179
  v_cvt_pk_bf16_f32 v178, v180, v181
  v_cvt_pk_bf16_f32 v179, v182, v183
  v_cvt_pk_bf16_f32 v180, v184, v185
  v_cvt_pk_bf16_f32 v181, v186, v187
  v_cvt_pk_bf16_f32 v182, v188, v189
  v_cvt_pk_bf16_f32 v183, v190, v191
  s_waitcnt lgkmcnt(0)
  v_mfma_f32_32x32x16_bf16 v[112:127], v[76:79], v[164:167], v[112:127]
  s_waitcnt vmcnt(5)
  s_barrier
  ds_read_b64_tr_b16 v[64:65], v7 offset:0
  ds_read_b64_tr_b16 v[66:67], v7 offset:1024
  ds_read_b64_tr_b16 v[68:69], v8 offset:0
  ds_read_b64_tr_b16 v[70:71], v8 offset:1024
  ds_read_b64_tr_b16 v[72:73], v7 offset:2048
  ds_read_b64_tr_b16 v[74:75], v7 offset:3072
  ds_read_b64_tr_b16 v[76:77], v8 offset:2048
  ds_read_b64_tr_b16 v[78:79], v8 offset:3072
  s_add_u32 m0, s52, 49152
  s_add_u32 s54, s64, 196608
  buffer_load_dwordx4 v6, s[24:27], s54 offen nt lds
  s_add_u32 s54, s54, 1024
  buffer_load_dwordx4 v6, s[24:27], s54 offen offset:1024 nt lds
  s_mov_b32 s56, 0x20000
Ltk_23:
  v_readfirstlane_b32 s54, v33
  s_nop 1
  s_cmp_lg_u32 s54, 0
  s_cbranch_scc1 Ltkd_24
  s_sub_u32 s56, s56, 1
  s_cmp_eq_u32 s56, 0
  s_cbranch_scc1 Ltkd_24
  s_sleep 8
  buffer_load_dword v33, v34, s[44:47], 0 offen sc1
  s_waitcnt vmcnt(0)
  s_branch Ltk_23
Ltkd_24:
  v_pk_fma_f32 v[192:193], v[192:193], s[60:61], v[24:25] op_sel_hi:[1,0,0]
  v_pk_fma_f32 v[194:195], v[194:195], s[60:61], v[24:25] op_sel_hi:[1,0,0]
  v_pk_fma_f32 v[196:197], v[196:197], s[60:61], v[24:25] op_sel_hi:[1,0,0]
  v_pk_fma_f32 v[198:199], v[198:199], s[60:61], v[24:25] op_sel_hi:[1,0,0]
  v_pk_fma_f32 v[200:201], v[200:201], s[60:61], v[24:25] op_sel_hi:[1,0,0]
  v_pk_fma_f32 v[202:203], v[202:203], s[60:61], v[24:25] op_sel_hi:[1,0,0]
  v_pk_fma_f32 v[204:205], v[204:205], s[60:61], v[24:25] op_sel_hi:[1,0,0]
  v_pk_fma_f32 v[206:207], v[206:207], s[60:61], v[24:25] op_sel_hi:[1,0,0]
  v_exp_f32 v192, v192
  v_exp_f32 v193, v193
  s_waitcnt lgkmcnt(6)
  v_mfma_f32_32x32x16_bf16 v[96:111], v[64:67], v[176:179], v[96:111]
  v_exp_f32 v194, v194
  v_exp_f32 v195, v195
  v_exp_f32 v196, v196
  v_exp_f32 v197, v197
  v_exp_f32 v198, v198
  v_exp_f32 v199, v199
  v_exp_f32 v200, v200
  v_exp_f32 v201, v201
  v_exp_f32 v202, v202
  v_exp_f32 v203, v203
  s_waitcnt lgkmcnt(4)
  v_mfma_f32_32x32x16_bf16 v[112:127], v[68:71], v[176:179], v[112:127]
  v_exp_f32 v204, v204
  v_exp_f32 v205, v205
  v_exp_f32 v206, v206
  v_exp_f32 v207, v207
  v_pk_add_f32 v[22:23], v[22:23], v[192:193]
  v_pk_add_f32 v[22:23], v[22:23], v[194:195]
  v_pk_add_f32 v[22:23], v[22:23], v[196:197]
  v_pk_add_f32 v[22:23], v[22:23], v[198:199]
  v_pk_add_f32 v[22:23], v[22:23], v[200:201]
  v_pk_add_f32 v[22:23], v[22:23], v[202:203]
  s_waitcnt lgkmcnt(2)
  v_mfma_f32_32x32x16_bf16 v[96:111], v[72:75], v[180:183], v[96:111]
  v_pk_add_f32 v[22:23], v[22:23], v[204:205]
  v_pk_add_f32 v[22:23], v[22:23], v[206:207]
  v_cvt_pk_bf16_f32 v192, v192, v193
  v_cvt_pk_bf16_f32 v193, v194, v195
  v_cvt_pk_bf16_f32 v194, v196, v197
  v_cvt_pk_bf16_f32 v195, v198, v199
  v_cvt_pk_bf16_f32 v196, v200, v201
  v_cvt_pk_bf16_f32 v197, v202, v203
  v_cvt_pk_bf16_f32 v198, v204, v205
  v_cvt_pk_bf16_f32 v199, v206, v207
  s_waitcnt lgkmcnt(0)
  v_mfma_f32_32x32x16_bf16 v[112:127], v[76:79], v[180:183], v[112:127]
  s_waitcnt vmcnt(4)
  s_barrier
  ds_read_b64_tr_b16 v[64:65], v7 offset:32768
  ds_read_b64_tr_b16 v[66:67], v7 offset:33792
  ds_read_b64_tr_b16 v[68:69], v8 offset:32768
  ds_read_b64_tr_b16 v[70:71], v8 offset:33792
  ds_read_b64_tr_b16 v[72:73], v7 offset:34816
  ds_read_b64_tr_b16 v[74:75], v7 offset:35840
  ds_read_b64_tr_b16 v[76:77], v8 offset:34816
  ds_read_b64_tr_b16 v[78:79], v8 offset:35840
  s_add_u32 m0, s52, 0
  s_add_u32 s54, s64, 229376
  buffer_load_dwordx4 v6, s[24:27], s54 offen nt lds
  s_add_u32 s54, s54, 1024
  buffer_load_dwordx4 v6, s[24:27], s54 offen offset:1024 nt lds
  ds_read_b64_tr_b16 v[136:137], v17 offset:0
  ds_read_b64_tr_b16 v[138:139], v17 offset:9216
  ds_read_b64_tr_b16 v[140:141], v17 offset:32
  ds_read_b64_tr_b16 v[142:143], v17 offset:9248
  ds_read_b64_tr_b16 v[152:153], v17 offset:64
  ds_read_b64_tr_b16 v[154:155], v17 offset:9280
  ds_read_b64_tr_b16 v[156:157], v17 offset:96
  ds_read_b64_tr_b16 v[158:159], v17 offset:9312
  ds_read_b64_tr_b16 v[168:169], v18 offset:0
  ds_read_b64_tr_b16 v[170:171], v18 offset:9216
  v_pk_fma_f32 v[208:209], v[208:209], s[60:61], v[24:25] op_sel_hi:[1,0,0]
  v_pk_fma_f32 v[210:211], v[210:211], s[60:61], v[24:25] op_sel_hi:[1,0,0]
  v_pk_fma_f32 v[212:213], v[212:213], s[60:61], v[24:25] op_sel_hi:[1,0,0]
  v_pk_fma_f32 v[214:215], v[214:215], s[60:61], v[24:25] op_sel_hi:[1,0,0]
  v_pk_fma_f32 v[216:217], v[216:217], s[60:61], v[24:25] op_sel_hi:[1,0,0]
  v_pk_fma_f32 v[218:219], v[218:219], s[60:61], v[24:25] op_sel_hi:[1,0,0]
  v_pk_fma_f32 v[220:221], v[220:221], s[60:61], v[24:25] op_sel_hi:[1,0,0]
  v_pk_fma_f32 v[222:223], v[222:223], s[60:61], v[24:25] op_sel_hi:[1,0,0]
  v_exp_f32 v208, v208
  v_exp_f32 v209, v209
  s_waitcnt lgkmcnt(15)
  v_mfma_f32_32x32x16_bf16 v[96:111], v[64:67], v[192:195], v[96:111]
  v_exp_f32 v210, v210
  v_exp_f32 v211, v211
  v_exp_f32 v212, v212
  v_exp_f32 v213, v213
  v_exp_f32 v214, v214
  v_exp_f32 v215, v215
  v_exp_f32 v216, v216
  v_exp_f32 v217, v217
  v_exp_f32 v218, v218
  v_exp_f32 v219, v219
  s_waitcnt lgkmcnt(14)
  v_mfma_f32_32x32x16_bf16 v[112:127], v[68:71], v[192:195], v[112:127]
  v_exp_f32 v220, v220
  v_exp_f32 v221, v221
  v_exp_f32 v222, v222
  v_exp_f32 v223, v223
  v_pk_add_f32 v[22:23], v[22:23], v[208:209]
  v_pk_add_f32 v[22:23], v[22:23], v[210:211]
  v_pk_add_f32 v[22:23], v[22:23], v[212:213]
  v_pk_add_f32 v[22:23], v[22:23], v[214:215]
  v_pk_add_f32 v[22:23], v[22:23], v[216:217]
  v_pk_add_f32 v[22:23], v[22:23], v[218:219]
  s_waitcnt lgkmcnt(12)
  v_mfma_f32_32x32x16_bf16 v[96:111], v[72:75], v[196:199], v[96:111]
  v_pk_add_f32 v[22:23], v[22:23], v[220:221]
  v_pk_add_f32 v[22:23], v[22:23], v[222:223]
  v_cvt_pk_bf16_f32 v208, v208, v209
  v_cvt_pk_bf16_f32 v209, v210, v211
  v_cvt_pk_bf16_f32 v210, v212, v213
  v_cvt_pk_bf16_f32 v211, v214, v215
  v_cvt_pk_bf16_f32 v212, v216, v217
  v_cvt_pk_bf16_f32 v213, v218, v219
  v_cvt_pk_bf16_f32 v214, v220, v221
  v_cvt_pk_bf16_f32 v215, v222, v223
  s_waitcnt lgkmcnt(10)
  v_mfma_f32_32x32x16_bf16 v[112:127], v[76:79], v[196:199], v[112:127]
  s_waitcnt vmcnt(4)
  s_waitcnt lgkmcnt(0)
  s_barrier
  ds_read_b64_tr_b16 v[64:65], v7 offset:16384
  ds_read_b64_tr_b16 v[66:67], v7 offset:17408
  ds_read_b64_tr_b16 v[68:69], v8 offset:16384
  ds_read_b64_tr_b16 v[70:71], v8 offset:17408
  ds_read_b64_tr_b16 v[72:73], v7 offset:18432
  ds_read_b64_tr_b16 v[74:75], v7 offset:19456
  ds_read_b64_tr_b16 v[76:77], v8 offset:18432
  ds_read_b64_tr_b16 v[78:79], v8 offset:19456
  s_add_u32 m0, s65, 114688
  s_add_u32 s54, s58, 147456
  buffer_load_dwordx4 v1, s[36:39], s54 offen lds
  s_add_u32 m0, s65, 122880
  s_add_u32 s54, s58, 155648
  buffer_load_dwordx4 v1, s[36:39], s54 offen lds
  s_add_u32 m0, s65, 131072
  s_add_u32 s54, s58, 163840
  buffer_load_dwordx4 v1, s[36:39], s54 offen lds
  s_add_u32 m0, s52, 32768
  s_xor_b32 s54, s64, 0x80
  s_add_u32 s54, s54, 0
  buffer_load_dwordx4 v6, s[24:27], s54 offen nt lds
  s_add_u32 s54, s54, 1024
  buffer_load_dwordx4 v6, s[24:27], s54 offen offset:1024 nt lds
  v_pk_fma_f32 v[224:225], v[224:225], s[60:61], v[24:25] op_sel_hi:[1,0,0]
  v_pk_fma_f32 v[226:227], v[226:227], s[60:61], v[24:25] op_sel_hi:[1,0,0]
  v_pk_fma_f32 v[228:229], v[228:229], s[60:61], v[24:25] op_sel_hi:[1,0,0]
  v_pk_fma_f32 v[230:231], v[230:231], s[60:61], v[24:25] op_sel_hi:[1,0,0]
  v_pk_fma_f32 v[232:233], v[232:233], s[60:61], v[24:25] op_sel_hi:[1,0,0]
  v_pk_fma_f32 v[234:235], v[234:235], s[60:61], v[24:25] op_sel_hi:[1,0,0]
  v_pk_fma_f32 v[236:237], v[236:237], s[60:61], v[24:25] op_sel_hi:[1,0,0]
  v_pk_fma_f32 v[238:239], v[238:239], s[60:61], v[24:25] op_sel_hi:[1,0,0]
  v_exp_f32 v224, v224
  v_exp_f32 v225, v225
  s_waitcnt lgkmcnt(6)
  v_mfma_f32_32x32x16_bf16 v[96:111], v[64:67], v[208:211], v[96:111]
  v_exp_f32 v226, v226
  v_exp_f32 v227, v227
  v_exp_f32 v228, v228
  v_exp_f32 v229, v229
  v_exp_f32 v230, v230
  v_exp_f32 v231, v231
  v_exp_f32 v232, v232
  v_exp_f32 v233, v233
  v_exp_f32 v234, v234
  v_exp_f32 v235, v235
  s_waitcnt lgkmcnt(4)
  v_mfma_f32_32x32x16_bf16 v[112:127], v[68:71], v[208:211], v[112:127]
  v_exp_f32 v236, v236
  v_exp_f32 v237, v237
  v_exp_f32 v238, v238
  v_exp_f32 v239, v239
  v_pk_add_f32 v[22:23], v[22:23], v[224:225]
  v_pk_add_f32 v[22:23], v[22:23], v[226:227]
  v_pk_add_f32 v[22:23], v[22:23], v[228:229]
  v_pk_add_f32 v[22:23], v[22:23], v[230:231]
  v_pk_add_f32 v[22:23], v[22:23], v[232:233]
  v_pk_add_f32 v[22:23], v[22:23], v[234:235]
  s_waitcnt lgkmcnt(2)
  v_mfma_f32_32x32x16_bf16 v[96:111], v[72:75], v[212:215], v[96:111]
  v_pk_add_f32 v[22:23], v[22:23], v[236:237]
  v_pk_add_f32 v[22:23], v[22:23], v[238:239]
  v_cvt_pk_bf16_f32 v224, v224, v225
  v_cvt_pk_bf16_f32 v225, v226, v227
  v_cvt_pk_bf16_f32 v226, v228, v229
  v_cvt_pk_bf16_f32 v227, v230, v231
  v_cvt_pk_bf16_f32 v228, v232, v233
  v_cvt_pk_bf16_f32 v229, v234, v235
  v_cvt_pk_bf16_f32 v230, v236, v237
  v_cvt_pk_bf16_f32 v231, v238, v239
  s_waitcnt lgkmcnt(0)
  v_mfma_f32_32x32x16_bf16 v[112:127], v[76:79], v[212:215], v[112:127]
  s_waitcnt vmcnt(7)
  s_barrier
  ds_read_b64_tr_b16 v[64:65], v7 offset:49152
  ds_read_b64_tr_b16 v[66:67], v7 offset:50176
  ds_read_b64_tr_b16 v[68:69], v8 offset:49152
  ds_read_b64_tr_b16 v[70:71], v8 offset:50176
  ds_read_b64_tr_b16 v[72:73], v7 offset:51200
  ds_read_b64_tr_b16 v[74:75], v7 offset:52224
  ds_read_b64_tr_b16 v[76:77], v8 offset:51200
  ds_read_b64_tr_b16 v[78:79], v8 offset:52224
  s_add_u32 m0, s65, 139264
  s_add_u32 s54, s58, 172032
  buffer_load_dwordx4 v1, s[36:39], s54 offen lds
  s_add_u32 m0, s65, 147456
  s_add_u32 s54, s58, 180224
  buffer_load_dwordx4 v1, s[36:39], s54 offen lds
  s_add_u32 m0, s52, 16384
  s_xor_b32 s54, s64, 0x80
  s_add_u32 s54, s54, 32768
  buffer_load_dwordx4 v6, s[24:27], s54 offen nt lds
  s_add_u32 s54, s54, 1024
  buffer_load_dwordx4 v6, s[24:27], s54 offen offset:1024 nt lds
  v_pk_fma_f32 v[240:241], v[240:241], s[60:61], v[24:25] op_sel_hi:[1,0,0]
  v_pk_fma_f32 v[242:243], v[242:243], s[60:61], v[24:25] op_sel_hi:[1,0,0]
  v_pk_fma_f32 v[244:245], v[244:245], s[60:61], v[24:25] op_sel_hi:[1,0,0]
  v_pk_fma_f32 v[246:247], v[246:247], s[60:61], v[24:25] op_sel_hi:[1,0,0]
  v_pk_fma_f32 v[248:249], v[248:249], s[60:61], v[24:25] op_sel_hi:[1,0,0]
  v_pk_fma_f32 v[250:251], v[250:251], s[60:61], v[24:25] op_sel_hi:[1,0,0]
  v_pk_fma_f32 v[252:253], v[252:253], s[60:61], v[24:25] op_sel_hi:[1,0,0]
  v_pk_fma_f32 v[254:255], v[254:255], s[60:61], v[24:25] op_sel_hi:[1,0,0]
  v_exp_f32 v240, v240
  v_exp_f32 v241, v241
  s_waitcnt lgkmcnt(6)
  v_mfma_f32_32x32x16_bf16 v[96:111], v[64:67], v[224:227], v[96:111]
  v_exp_f32 v242, v242
  v_exp_f32 v243, v243
  v_exp_f32 v244, v244
  v_exp_f32 v245, v245
  v_exp_f32 v246, v246
  v_exp_f32 v247, v247
  v_exp_f32 v248, v248
  v_exp_f32 v249, v249
  v_exp_f32 v250, v250
  v_exp_f32 v251, v251
  s_waitcnt lgkmcnt(4)
  v_mfma_f32_32x32x16_bf16 v[112:127], v[68:71], v[224:227], v[112:127]
  v_exp_f32 v252, v252
  v_exp_f32 v253, v253
  v_exp_f32 v254, v254
  v_exp_f32 v255, v255
  v_pk_add_f32 v[22:23], v[22:23], v[240:241]
  v_pk_add_f32 v[22:23], v[22:23], v[242:243]
  v_pk_add_f32 v[22:23], v[22:23], v[244:245]
  v_pk_add_f32 v[22:23], v[22:23], v[246:247]
  v_pk_add_f32 v[22:23], v[22:23], v[248:249]
  v_pk_add_f32 v[22:23], v[22:23], v[250:251]
  s_waitcnt lgkmcnt(2)
  v_mfma_f32_32x32x16_bf16 v[96:111], v[72:75], v[228:231], v[96:111]
  v_pk_add_f32 v[22:23], v[22:23], v[252:253]
  v_pk_add_f32 v[22:23], v[22:23], v[254:255]
  v_cvt_pk_bf16_f32 v240, v240, v241
  v_cvt_pk_bf16_f32 v241, v242, v243
  v_cvt_pk_bf16_f32 v242, v244, v245
  v_cvt_pk_bf16_f32 v243, v246, v247
  v_cvt_pk_bf16_f32 v244, v248, v249
  v_cvt_pk_bf16_f32 v245, v250, v251
  v_cvt_pk_bf16_f32 v246, v252, v253
  v_cvt_pk_bf16_f32 v247, v254, v255
  s_waitcnt lgkmcnt(0)
  v_mfma_f32_32x32x16_bf16 v[112:127], v[76:79], v[228:231], v[112:127]
  v_add_f32 v22, v22, v23
  v_mov_b32 v28, v22
  s_nop 1
  v_permlane32_swap_b32 v22, v28
  v_add_f32 v22, v22, v28
  ds_write_b32 v20, v22 offset:1024
  s_waitcnt vmcnt(9)
  s_waitcnt lgkmcnt(0)
  s_barrier
  ds_read_b64_tr_b16 v[64:65], v7 offset:0
  ds_read_b64_tr_b16 v[66:67], v7 offset:1024
  ds_read_b64_tr_b16 v[68:69], v8 offset:0
  ds_read_b64_tr_b16 v[70:71], v8 offset:1024
  ds_read_b64_tr_b16 v[72:73], v7 offset:2048
  ds_read_b64_tr_b16 v[74:75], v7 offset:3072
  ds_read_b64_tr_b16 v[76:77], v8 offset:2048
  ds_read_b64_tr_b16 v[78:79], v8 offset:3072
  s_add_u32 m0, s52, 49152
  s_xor_b32 s54, s64, 0x80
  s_add_u32 s54, s54, 65536
  buffer_load_dwordx4 v6, s[24:27], s54 offen nt lds
  s_add_u32 s54, s54, 1024
  buffer_load_dwordx4 v6, s[24:27], s54 offen offset:1024 nt lds
  ds_read_b128 v[80:83], v19 offset:1024
  s_xor_b32 s62, s2, 16
  s_lshl_b32 s62, s62, 14
  s_add_u32 s62, s62, 0x1100000
  s_add_u32 s62, s62, s52
  s_waitcnt lgkmcnt(0)
  v_add_f32 v80, v80, v81
  v_add_f32 v82, v82, v83
  v_add_f32 v80, v80, v82
  v_log_f32 v81, v80
  v_rcp_f32 v37, v80
  v_sub_f32 v36, v81, v24
  v_mfma_f32_32x32x16_bf16 v[96:111], v[64:67], v[240:243], v[96:111]
  v_mfma_f32_32x32x16_bf16 v[112:127], v[68:71], v[240:243], v[112:127]
  v_mfma_f32_32x32x16_bf16 v[96:111], v[72:75], v[244:247], v[96:111]
  v_mfma_f32_32x32x16_bf16 v[112:127], v[76:79], v[244:247], v[112:127]
  v_xor_b32 v29, 2048, v27
  v_xor_b32 v30, 4096, v27
  v_xor_b32 v31, 6144, v27
  s_nop 7
  ds_write_b128 v29, v[104:107] offset:0
  ds_write_b128 v29, v[108:111] offset:1024
  ds_write_b128 v30, v[112:115] offset:16384
  ds_write_b128 v30, v[116:119] offset:17408
  ds_write_b128 v31, v[120:123] offset:32768
  ds_write_b128 v31, v[124:127] offset:33792
  v_mov_b32 v80, v96
  v_mov_b32 v81, v97
  v_mov_b32 v82, v98
  v_mov_b32 v83, v99
  v_mov_b32 v84, v100
  v_mov_b32 v85, v101
  v_mov_b32 v86, v102
  v_mov_b32 v87, v103
  s_waitcnt vmcnt(4)
  s_waitcnt lgkmcnt(0)
  s_barrier
  ds_read_b64_tr_b16 v[64:65], v7 offset:32768
  ds_read_b64_tr_b16 v[66:67], v7 offset:33792
  ds_read_b64_tr_b16 v[68:69], v8 offset:32768
  ds_read_b64_tr_b16 v[70:71], v8 offset:33792
  ds_read_b64_tr_b16 v[72:73], v7 offset:34816
  ds_read_b64_tr_b16 v[74:75], v7 offset:35840
  ds_read_b64_tr_b16 v[76:77], v8 offset:34816
  ds_read_b64_tr_b16 v[78:79], v8 offset:35840
  s_add_u32 m0, s52, 0
  s_xor_b32 s54, s64, 0x80
  s_add_u32 s54, s54, 98304
  buffer_load_dwordx4 v6, s[24:27], s54 offen nt lds
  s_add_u32 s54, s54, 1024
  buffer_load_dwordx4 v6, s[24:27], s54 offen offset:1024 nt lds
  ds_read_b128 v[88:91], v27 offset:0
  ds_read_b128 v[92:95], v27 offset:1024
  s_waitcnt lgkmcnt(1)
  v_pk_add_f32 v[80:81], v[80:81], v[88:89]
  v_pk_add_f32 v[82:83], v[82:83], v[90:91]
  s_waitcnt lgkmcnt(0)
  v_pk_add_f32 v[84:85], v[84:85], v[92:93]
  v_pk_add_f32 v[86:87], v[86:87], v[94:95]
  ds_read_b128 v[88:91], v27 offset:16384
  ds_read_b128 v[92:95], v27 offset:17408
  s_waitcnt lgkmcnt(1)
  v_pk_add_f32 v[80:81], v[80:81], v[88:89]
  v_pk_add_f32 v[82:83], v[82:83], v[90:91]
  s_waitcnt lgkmcnt(0)
  v_pk_add_f32 v[84:85], v[84:85], v[92:93]
  v_pk_add_f32 v[86:87], v[86:87], v[94:95]
  ds_read_b128 v[88:91], v27 offset:32768
  ds_read_b128 v[92:95], v27 offset:33792
  s_waitcnt lgkmcnt(1)
  v_pk_add_f32 v[80:81], v[80:81], v[88:89]
  v_pk_add_f32 v[82:83], v[82:83], v[90:91]
  s_waitcnt lgkmcnt(0)
  v_pk_add_f32 v[84:85], v[84:85], v[92:93]
  v_pk_add_f32 v[86:87], v[86:87], v[94:95]
  v_mul_f32 v80, v80, v37
  v_mul_f32 v81, v81, v37
  v_mul_f32 v82, v82, v37
  v_mul_f32 v83, v83, v37
  v_mul_f32 v84, v84, v37
  v_mul_f32 v85, v85, v37
  v_mul_f32 v86, v86, v37
  v_mul_f32 v87, v87, v37
  s_xor_b32 s54, s62, 0x40000
  v_cvt_pk_bf16_f32 v92, v86, v87
  v_cvt_pk_bf16_f32 v93, v86, v87
  v_cvt_pk_bf16_f32 v88, v80, v81
  v_cvt_pk_bf16_f32 v89, v82, v83
  v_cvt_pk_bf16_f32 v90, v84, v85
  v_mov_b32 v91, v33
  v_permlane32_swap_b32 v92, v93
  v_and_b32 v9, 0x1ff, v1
  buffer_store_dwordx4 v[88:91], v1, s[40:43], s54 offen sc1
  v_mov_b32 v94, v36
  v_mov_b32 v95, v33
  s_mov_b32 exec_hi, 0
  buffer_store_dwordx4 v[92:95], v1, s[40:43], s54 offen offset:1024 sc1
  s_mov_b64 exec, -1
  ds_read_b64_tr_b16 v[172:173], v17 offset:0
  ds_read_b64_tr_b16 v[174:175], v17 offset:9216
  ds_read_b64_tr_b16 v[184:185], v17 offset:32
  ds_read_b64_tr_b16 v[186:187], v17 offset:9248
  ds_read_b64_tr_b16 v[188:189], v17 offset:64
  ds_read_b64_tr_b16 v[190:191], v17 offset:9280
  ds_read_b64_tr_b16 v[200:201], v17 offset:96
  ds_read_b64_tr_b16 v[202:203], v17 offset:9312
  ds_read_b64_tr_b16 v[204:205], v18 offset:0
  ds_read_b64_tr_b16 v[206:207], v18 offset:9216
  v_mfma_f32_32x32x16_bf16 v[96:111], v[64:67], v[128:131], 0
  v_mfma_f32_32x32x16_bf16 v[112:127], v[68:71], v[128:131], 0
  v_mfma_f32_32x32x16_bf16 v[96:111], v[72:75], v[132:135], v[96:111]
  v_mfma_f32_32x32x16_bf16 v[112:127], v[76:79], v[132:135], v[112:127]
  s_waitcnt vmcnt(6)
  s_waitcnt lgkmcnt(0)
  s_barrier
  ds_read_b64_tr_b16 v[64:65], v7 offset:16384
  ds_read_b64_tr_b16 v[66:67], v7 offset:17408
  ds_read_b64_tr_b16 v[68:69], v8 offset:16384
  ds_read_b64_tr_b16 v[70:71], v8 offset:17408
  ds_read_b64_tr_b16 v[72:73], v7 offset:18432
  ds_read_b64_tr_b16 v[74:75], v7 offset:19456
  ds_read_b64_tr_b16 v[76:77], v8 offset:18432
  ds_read_b64_tr_b16 v[78:79], v8 offset:19456
  s_add_u32 m0, s65, 114688
  s_add_u32 s54, s58, 184320
  buffer_load_dwordx4 v1, s[36:39], s54 offen lds
  s_add_u32 m0, s65, 122880
  s_add_u32 s54, s58, 192512
  buffer_load_dwordx4 v1, s[36:39], s54 offen lds
  s_add_u32 m0, s52, 32768
  s_xor_b32 s54, s64, 0x80
  s_add_u32 s54, s54, 131072
  buffer_load_dwordx4 v6, s[24:27], s54 offen nt lds
  s_add_u32 s54, s54, 1024
  buffer_load_dwordx4 v6, s[24:27], s54 offen offset:1024 nt lds
  s_waitcnt lgkmcnt(6)
  v_mfma_f32_32x32x16_bf16 v[96:111], v[64:67], v[144:147], v[96:111]
  s_waitcnt lgkmcnt(4)
  v_mfma_f32_32x32x16_bf16 v[112:127], v[68:71], v[144:147], v[112:127]
  s_waitcnt lgkmcnt(2)
  v_mfma_f32_32x32x16_bf16 v[96:111], v[72:75], v[148:151], v[96:111]
  s_waitcnt lgkmcnt(0)
  v_mfma_f32_32x32x16_bf16 v[112:127], v[76:79], v[148:151], v[112:127]
  s_waitcnt vmcnt(8)
  s_barrier
  ds_read_b64_tr_b16 v[64:65], v7 offset:49152
  ds_read_b64_tr_b16 v[66:67], v7 offset:50176
  ds_read_b64_tr_b16 v[68:69], v8 offset:49152
  ds_read_b64_tr_b16 v[70:71], v8 offset:50176
  ds_read_b64_tr_b16 v[72:73], v7 offset:51200
  ds_read_b64_tr_b16 v[74:75], v7 offset:52224
  ds_read_b64_tr_b16 v[76:77], v8 offset:51200
  ds_read_b64_tr_b16 v[78:79], v8 offset:52224
  s_add_u32 m0, s65, 131072
  s_add_u32 s54, s58, 200704
  buffer_load_dwordx4 v1, s[36:39], s54 offen lds
  s_add_u32 m0, s65, 139264
  s_add_u32 s54, s58, 208896
  buffer_load_dwordx4 v1, s[36:39], s54 offen lds
  s_add_u32 m0, s52, 16384
  s_xor_b32 s54, s64, 0x80
  s_add_u32 s54, s54, 163840
  buffer_load_dwordx4 v6, s[24:27], s54 offen nt lds
  s_add_u32 s54, s54, 1024
  buffer_load_dwordx4 v6, s[24:27], s54 offen offset:1024 nt lds
  s_mov_b32 s28, s14
  s_mov_b32 s29, s15
  s_mov_b32 s30, 294912
  s_mov_b32 s31, 0x20000
  s_lshl_b32 s54, s48, 6
  v_add_u32 v15, s54, v0
  v_and_b32 v16, 0xff, v15
  v_lshrrev_b32 v28, 2, v16
  v_and_b32 v29, 3, v16
  v_lshlrev_b32 v29, 8, v29
  v_lshl_add_u32 v29, v28, 3, v29
  v_add_u32 v29, 0x800, v29
  v_lshlrev_b32 v11, 3, v16
  v_cmp_lt_u32 vcc, 0xff, v15
  s_nop 1
  v_cndmask_b32 v11, v11, v29, vcc
  v_add_u32 v11, 0x10000, v11
  v_add_u32 v28, 0x100, v28
  v_cndmask_b32 v16, v16, v28, vcc
  s_and_b32 s54, s2, 31
  s_mul_i32 s54, s54, 288
  v_add_u32 v16, s54, v16
  v_bfe_u32 v28, v16, 1, 6
  v_lshlrev_b32 v28, 2, v28
  v_bfe_u32 v29, v16, 7, 1
  v_lshl_or_b32 v28, v29, 1, v28
  v_and_b32 v29, 0xff01, v16
  v_or_b32 v28, v28, v29
  v_cmp_lt_u32 vcc, 0x1fff, v16
  s_nop 1
  v_cndmask_b32 v16, v16, v28, vcc
  v_bfe_u32 v28, v16, 2, 4
  v_bfe_u32 v29, v16, 1, 1
  v_lshl_add_u32 v28, v29, 4, v28
  v_mul_u32_u24 v28, 1152, v28
  v_lshrrev_b32 v29, 6, v16
  v_lshl_add_u32 v28, v29, 3, v28
  v_and_b32 v29, 1, v16
  v_lshl_add_u32 v28, v29, 2, v28
  s_mul_i32 s54, s50, 36864
  v_add_u32 v28, s54, v28
  v_and_b32 v29, 0x103, v15
  v_cmp_lt_u32 vcc, 0x100, v29
  v_mov_b32 v29, 0x7fffffff
  s_nop 0
  v_cndmask_b32 v10, v28, v29, vcc
  v_bfe_u32 v28, v0, 3, 2
  v_mul_u32_u24 v28, 36864, v28
  v_and_b32 v29, 7, v0
  v_lshl_add_u32 v28, v29, 4, v28
  v_add_u32 v12, 0x400, v28
  v_and_b32 v28, 31, v0
  v_lshlrev_b32 v13, 7, v28
  v_and_b32 v28, 3, v0
  v_lshlrev_b32 v14, 2, v28
  s_waitcnt lgkmcnt(6)
  v_mfma_f32_32x32x16_bf16 v[96:111], v[64:67], v[160:163], v[96:111]
  s_waitcnt lgkmcnt(4)
  v_mfma_f32_32x32x16_bf16 v[112:127], v[68:71], v[160:163], v[112:127]
  s_waitcnt lgkmcnt(2)
  v_mfma_f32_32x32x16_bf16 v[96:111], v[72:75], v[164:167], v[96:111]
  s_waitcnt lgkmcnt(0)
  v_mfma_f32_32x32x16_bf16 v[112:127], v[76:79], v[164:167], v[112:127]
  s_waitcnt vmcnt(10)
  s_barrier
  ds_read_b64_tr_b16 v[64:65], v7 offset:0
  ds_read_b64_tr_b16 v[66:67], v7 offset:1024
  ds_read_b64_tr_b16 v[68:69], v8 offset:0
  ds_read_b64_tr_b16 v[70:71], v8 offset:1024
  ds_read_b64_tr_b16 v[72:73], v7 offset:2048
  ds_read_b64_tr_b16 v[74:75], v7 offset:3072
  ds_read_b64_tr_b16 v[76:77], v8 offset:2048
  ds_read_b64_tr_b16 v[78:79], v8 offset:3072
  s_add_u32 m0, s65, 147456
  s_add_u32 s54, s58, 217088
  buffer_load_dwordx4 v1, s[36:39], s54 offen lds
  s_add_u32 m0, s52, 49152
  s_xor_b32 s54, s64, 0x80
  s_add_u32 s54, s54, 196608
  buffer_load_dwordx4 v6, s[24:27], s54 offen nt lds
  s_add_u32 s54, s54, 1024
  buffer_load_dwordx4 v6, s[24:27], s54 offen offset:1024 nt lds
  s_waitcnt lgkmcnt(6)
  v_mfma_f32_32x32x16_bf16 v[96:111], v[64:67], v[176:179], v[96:111]
  s_waitcnt lgkmcnt(4)
  v_mfma_f32_32x32x16_bf16 v[112:127], v[68:71], v[176:179], v[112:127]
  s_waitcnt lgkmcnt(2)
  v_mfma_f32_32x32x16_bf16 v[96:111], v[72:75], v[180:183], v[96:111]
  s_waitcnt lgkmcnt(0)
  v_mfma_f32_32x32x16_bf16 v[112:127], v[76:79], v[180:183], v[112:127]
  s_waitcnt vmcnt(7)
  s_barrier
  ds_read_b64_tr_b16 v[64:65], v7 offset:32768
  ds_read_b64_tr_b16 v[66:67], v7 offset:33792
  ds_read_b64_tr_b16 v[68:69], v8 offset:32768
  ds_read_b64_tr_b16 v[70:71], v8 offset:33792
  ds_read_b64_tr_b16 v[72:73], v7 offset:34816
  ds_read_b64_tr_b16 v[74:75], v7 offset:35840
  ds_read_b64_tr_b16 v[76:77], v8 offset:34816
  ds_read_b64_tr_b16 v[78:79], v8 offset:35840
  s_add_u32 m0, s52, 0
  s_xor_b32 s54, s64, 0x80
  s_add_u32 s54, s54, 229376
  buffer_load_dwordx4 v6, s[24:27], s54 offen nt lds
  s_add_u32 s54, s54, 1024
  buffer_load_dwordx4 v6, s[24:27], s54 offen offset:1024 nt lds
  s_waitcnt lgkmcnt(6)
  v_mfma_f32_32x32x16_bf16 v[96:111], v[64:67], v[192:195], v[96:111]
  s_waitcnt lgkmcnt(4)
  v_mfma_f32_32x32x16_bf16 v[112:127], v[68:71], v[192:195], v[112:127]
  s_waitcnt lgkmcnt(2)
  v_mfma_f32_32x32x16_bf16 v[96:111], v[72:75], v[196:199], v[96:111]
  s_waitcnt lgkmcnt(0)
  v_mfma_f32_32x32x16_bf16 v[112:127], v[76:79], v[196:199], v[112:127]
  s_waitcnt vmcnt(5)
  s_barrier
  ds_read_b64_tr_b16 v[64:65], v7 offset:16384
  ds_read_b64_tr_b16 v[66:67], v7 offset:17408
  ds_read_b64_tr_b16 v[68:69], v8 offset:16384
  ds_read_b64_tr_b16 v[70:71], v8 offset:17408
  ds_read_b64_tr_b16 v[72:73], v7 offset:18432
  ds_read_b64_tr_b16 v[74:75], v7 offset:19456
  ds_read_b64_tr_b16 v[76:77], v8 offset:18432
  ds_read_b64_tr_b16 v[78:79], v8 offset:19456
  buffer_load_dwordx4 v[40:43], v1, s[40:43], s62 offen sc1
  buffer_load_dwordx4 v[252:255], v9, s[40:43], s62 offen offset:1024 sc1
  s_waitcnt lgkmcnt(6)
  v_mfma_f32_32x32x16_bf16 v[96:111], v[64:67], v[208:211], v[96:111]
  s_waitcnt lgkmcnt(4)
  v_mfma_f32_32x32x16_bf16 v[112:127], v[68:71], v[208:211], v[112:127]
  s_waitcnt lgkmcnt(2)
  v_mfma_f32_32x32x16_bf16 v[96:111], v[72:75], v[212:215], v[96:111]
  s_waitcnt lgkmcnt(0)
  v_mfma_f32_32x32x16_bf16 v[112:127], v[76:79], v[212:215], v[112:127]
  s_waitcnt vmcnt(4)
  s_barrier
  ds_read_b64_tr_b16 v[64:65], v7 offset:49152
  ds_read_b64_tr_b16 v[66:67], v7 offset:50176
  ds_read_b64_tr_b16 v[68:69], v8 offset:49152
  ds_read_b64_tr_b16 v[70:71], v8 offset:50176
  ds_read_b64_tr_b16 v[72:73], v7 offset:51200
  ds_read_b64_tr_b16 v[74:75], v7 offset:52224
  ds_read_b64_tr_b16 v[76:77], v8 offset:51200
  ds_read_b64_tr_b16 v[78:79], v8 offset:52224
  ds_read_b64_tr_b16 v[216:217], v17 offset:0
  ds_read_b64_tr_b16 v[218:219], v17 offset:9216
  ds_read_b64_tr_b16 v[220:221], v17 offset:32
  ds_read_b64_tr_b16 v[222:223], v17 offset:9248
  ds_read_b64_tr_b16 v[232:233], v17 offset:64
  ds_read_b64_tr_b16 v[234:235], v17 offset:9280
  ds_read_b64_tr_b16 v[236:237], v17 offset:96
  ds_read_b64_tr_b16 v[238:239], v17 offset:9312
  ds_read_b64_tr_b16 v[248:249], v18 offset:0
  ds_read_b64_tr_b16 v[250:251], v18 offset:9216
  s_waitcnt lgkmcnt(15)
  v_mfma_f32_32x32x16_bf16 v[96:111], v[64:67], v[224:227], v[96:111]
  s_waitcnt lgkmcnt(14)
  v_mfma_f32_32x32x16_bf16 v[112:127], v[68:71], v[224:227], v[112:127]
  s_waitcnt lgkmcnt(12)
  v_mfma_f32_32x32x16_bf16 v[96:111], v[72:75], v[228:231], v[96:111]
  s_waitcnt lgkmcnt(10)
  v_mfma_f32_32x32x16_bf16 v[112:127], v[76:79], v[228:231], v[112:127]
  s_waitcnt vmcnt(2)
  s_waitcnt lgkmcnt(0)
  s_barrier
  ds_read_b64_tr_b16 v[64:65], v7 offset:0
  ds_read_b64_tr_b16 v[66:67], v7 offset:1024
  ds_read_b64_tr_b16 v[68:69], v8 offset:0
  ds_read_b64_tr_b16 v[70:71], v8 offset:1024
  ds_read_b64_tr_b16 v[72:73], v7 offset:2048
  ds_read_b64_tr_b16 v[74:75], v7 offset:3072
  ds_read_b64_tr_b16 v[76:77], v8 offset:2048
  ds_read_b64_tr_b16 v[78:79], v8 offset:3072
  s_waitcnt lgkmcnt(6)
  v_mfma_f32_32x32x16_bf16 v[96:111], v[64:67], v[240:243], v[96:111]
  s_waitcnt lgkmcnt(4)
  v_mfma_f32_32x32x16_bf16 v[112:127], v[68:71], v[240:243], v[112:127]
  s_waitcnt lgkmcnt(2)
  v_mfma_f32_32x32x16_bf16 v[96:111], v[72:75], v[244:247], v[96:111]
  s_waitcnt lgkmcnt(0)
  v_mfma_f32_32x32x16_bf16 v[112:127], v[76:79], v[244:247], v[112:127]
  v_xor_b32 v29, 2048, v27
  v_xor_b32 v30, 4096, v27
  v_xor_b32 v31, 6144, v27
  s_nop 6
  ds_write_b128 v29, v[104:107] offset:0
  ds_write_b128 v29, v[108:111] offset:1024
  ds_write_b128 v30, v[112:115] offset:16384
  ds_write_b128 v30, v[116:119] offset:17408
  ds_write_b128 v31, v[120:123] offset:32768
  ds_write_b128 v31, v[124:127] offset:33792
  s_mov_b32 s56, 0x20000
Lrx_25:
  s_waitcnt vmcnt(0)
  v_xor_b32 v80, v43, v33
  v_xor_b32 v81, v255, v33
  v_or_b32 v80, v80, v81
  v_cmp_ne_u32 vcc, 0, v80
  s_nop 3
  s_cbranch_vccz Lrxd_26
  s_sub_u32 s56, s56, 1
  s_cmp_eq_u32 s56, 0
  s_cbranch_scc1 Lrxd_26
  s_sleep 8
  buffer_load_dwordx4 v[40:43], v1, s[40:43], s62 offen sc1
  buffer_load_dwordx4 v[252:255], v9, s[40:43], s62 offen offset:1024 sc1
  s_branch Lrx_25
Lrxd_26:
  s_mov_b32 s56, 0xffff0000
  v_sub_f32 v38, v36, v254
  v_sub_f32 v39, v254, v36
  v_cmp_lt_u32 vcc, 31, v0
  v_exp_f32 v38, v38
  v_exp_f32 v39, v39
  v_add_f32 v38, 1.0, v38
  v_add_f32 v39, 1.0, v39
  v_rcp_f32 v38, v38
  v_rcp_f32 v39, v39
  v_cndmask_b32 v252, v252, v253, vcc
  v_lshlrev_b32 v80, 16, v40
  v_and_b32 v81, s56, v40
  v_lshlrev_b32 v82, 16, v41
  v_and_b32 v83, s56, v41
  v_lshlrev_b32 v84, 16, v42
  v_and_b32 v85, s56, v42
  v_lshlrev_b32 v86, 16, v252
  v_and_b32 v87, s56, v252
  v_mul_f32 v39, v39, v37
  v_mul_f32 v80, v80, v38
  v_mul_f32 v81, v81, v38
  v_mul_f32 v82, v82, v38
  v_mul_f32 v83, v83, v38
  v_mul_f32 v84, v84, v38
  v_mul_f32 v85, v85, v38
  v_mul_f32 v86, v86, v38
  v_mul_f32 v87, v87, v38
  s_add_u32 s54, s65, 49152
  v_add_u32 v28, s54, v1
  s_and_b32 s55, s48, 1
  s_lshl_b32 s53, s55, 3
  s_lshl_b32 s54, s55, 8
  v_add_u32 v26, s54, v21
  s_waitcnt lgkmcnt(0)
  s_barrier
  ds_read_b128 v[104:107], v27 offset:0
  ds_read_b128 v[108:111], v27 offset:1024
  ds_read_b128 v[112:115], v27 offset:16384
  ds_read_b128 v[116:119], v27 offset:17408
  ds_read_b128 v[120:123], v27 offset:32768
  ds_read_b128 v[124:127], v27 offset:33792
  s_waitcnt lgkmcnt(5)
  v_pk_add_f32 v[96:97], v[96:97], v[104:105]
  v_pk_add_f32 v[98:99], v[98:99], v[106:107]
  s_waitcnt lgkmcnt(4)
  v_pk_add_f32 v[100:101], v[100:101], v[108:109]
  v_pk_add_f32 v[102:103], v[102:103], v[110:111]
  s_waitcnt lgkmcnt(3)
  v_pk_add_f32 v[96:97], v[96:97], v[112:113]
  v_pk_add_f32 v[98:99], v[98:99], v[114:115]
  s_waitcnt lgkmcnt(2)
  v_pk_add_f32 v[100:101], v[100:101], v[116:117]
  v_pk_add_f32 v[102:103], v[102:103], v[118:119]
  s_waitcnt lgkmcnt(1)
  v_pk_add_f32 v[96:97], v[96:97], v[120:121]
  v_pk_add_f32 v[98:99], v[98:99], v[122:123]
  s_waitcnt lgkmcnt(0)
  v_pk_add_f32 v[100:101], v[100:101], v[124:125]
  v_pk_add_f32 v[102:103], v[102:103], v[126:127]
  v_fma_f32 v96, v96, v39, v80
  v_fma_f32 v97, v97, v39, v81
  v_fma_f32 v98, v98, v39, v82
  v_fma_f32 v99, v99, v39, v83
  v_fma_f32 v100, v100, v39, v84
  v_fma_f32 v101, v101, v39, v85
  v_fma_f32 v102, v102, v39, v86
  v_fma_f32 v103, v103, v39, v87
  v_cvt_pk_bf16_f32 v80, v96, v97
  v_cvt_pk_bf16_f32 v81, v98, v99
  v_cvt_pk_bf16_f32 v82, v100, v101
  v_cvt_pk_bf16_f32 v83, v102, v103
  ds_write_b128 v28, v[80:83]
  s_waitcnt lgkmcnt(0)
  s_barrier
  ds_read_b128 v[128:131], v21 offset:49152
  ds_read_b128 v[132:135], v21 offset:49408
  ds_read_b128 v[144:147], v21 offset:51200
  ds_read_b128 v[148:151], v21 offset:51456
  ds_read_b128 v[160:163], v21 offset:53248
  ds_read_b128 v[164:167], v21 offset:53504
  ds_read_b128 v[176:179], v21 offset:55296
  ds_read_b128 v[180:183], v21 offset:55552
  ds_read_b128 v[192:195], v26 offset:49152
  ds_read_b128 v[196:199], v26 offset:51200
  ds_read_b128 v[208:211], v26 offset:53248
  ds_read_b128 v[212:215], v26 offset:55296
  s_mul_i32 s54, s2, 36864
  s_lshl_b32 s56, s48, 9
  v_lshlrev_b32 v29, 3, v0
  s_add_u32 s56, s56, s54
  s_add_u32 s56, s56, 32768
  s_lshl_b32 s55, s48, 12
  s_add_u32 s54, s54, s55
  s_waitcnt lgkmcnt(11)
  v_mfma_f32_16x16x32_bf16 v[84:87], v[44:47], v[128:131], 0
  s_waitcnt lgkmcnt(10)
  v_mfma_f32_16x16x32_bf16 v[88:91], v[44:47], v[132:135], 0
  s_waitcnt lgkmcnt(9)
  v_mfma_f32_16x16x32_bf16 v[84:87], v[136:139], v[144:147], v[84:87]
  s_waitcnt lgkmcnt(8)
  v_mfma_f32_16x16x32_bf16 v[88:91], v[136:139], v[148:151], v[88:91]
  s_waitcnt lgkmcnt(7)
  v_mfma_f32_16x16x32_bf16 v[84:87], v[172:175], v[160:163], v[84:87]
  s_waitcnt lgkmcnt(6)
  v_mfma_f32_16x16x32_bf16 v[88:91], v[172:175], v[164:167], v[88:91]
  s_waitcnt lgkmcnt(5)
  v_mfma_f32_16x16x32_bf16 v[84:87], v[216:219], v[176:179], v[84:87]
  s_waitcnt lgkmcnt(4)
  v_mfma_f32_16x16x32_bf16 v[88:91], v[216:219], v[180:183], v[88:91]
  s_waitcnt lgkmcnt(3)
  v_mfma_f32_16x16x32_bf16 v[116:119], v[60:63], v[192:195], 0
  v_mfma_f32_16x16x32_bf16 v[92:95], v[48:51], v[128:131], 0
  v_mfma_f32_16x16x32_bf16 v[96:99], v[48:51], v[132:135], 0
  v_mfma_f32_16x16x32_bf16 v[92:95], v[140:143], v[144:147], v[92:95]
  v_mfma_f32_16x16x32_bf16 v[96:99], v[140:143], v[148:151], v[96:99]
  v_mfma_f32_16x16x32_bf16 v[92:95], v[184:187], v[160:163], v[92:95]
  v_mfma_f32_16x16x32_bf16 v[96:99], v[184:187], v[164:167], v[96:99]
  v_mfma_f32_16x16x32_bf16 v[92:95], v[220:223], v[176:179], v[92:95]
  v_mfma_f32_16x16x32_bf16 v[96:99], v[220:223], v[180:183], v[96:99]
  s_waitcnt lgkmcnt(2)
  v_mfma_f32_16x16x32_bf16 v[116:119], v[168:171], v[196:199], v[116:119]
  v_cvt_pk_bf16_f32 v120, v84, v85
  v_cvt_pk_bf16_f32 v121, v86, v87
  v_cvt_pk_bf16_f32 v122, v88, v89
  v_cvt_pk_bf16_f32 v123, v90, v91
  buffer_store_dwordx4 v[120:123], v1, s[40:43], s54 offen offset:0 sc1
  v_mfma_f32_16x16x32_bf16 v[100:103], v[52:55], v[128:131], 0
  v_mfma_f32_16x16x32_bf16 v[104:107], v[52:55], v[132:135], 0
  v_mfma_f32_16x16x32_bf16 v[100:103], v[152:155], v[144:147], v[100:103]
  v_mfma_f32_16x16x32_bf16 v[104:107], v[152:155], v[148:151], v[104:107]
  v_mfma_f32_16x16x32_bf16 v[100:103], v[188:191], v[160:163], v[100:103]
  v_mfma_f32_16x16x32_bf16 v[104:107], v[188:191], v[164:167], v[104:107]
  v_mfma_f32_16x16x32_bf16 v[100:103], v[232:235], v[176:179], v[100:103]
  v_mfma_f32_16x16x32_bf16 v[104:107], v[232:235], v[180:183], v[104:107]
  s_waitcnt lgkmcnt(1)
  v_mfma_f32_16x16x32_bf16 v[116:119], v[204:207], v[208:211], v[116:119]
  v_cvt_pk_bf16_f32 v124, v92, v93
  v_cvt_pk_bf16_f32 v125, v94, v95
  v_cvt_pk_bf16_f32 v126, v96, v97
  v_cvt_pk_bf16_f32 v127, v98, v99
  buffer_store_dwordx4 v[124:127], v1, s[40:43], s54 offen offset:1024 sc1
  v_mfma_f32_16x16x32_bf16 v[108:111], v[56:59], v[128:131], 0
  v_mfma_f32_16x16x32_bf16 v[112:115], v[56:59], v[132:135], 0
  v_mfma_f32_16x16x32_bf16 v[108:111], v[156:159], v[144:147], v[108:111]
  v_mfma_f32_16x16x32_bf16 v[112:115], v[156:159], v[148:151], v[112:115]
  v_mfma_f32_16x16x32_bf16 v[108:111], v[200:203], v[160:163], v[108:111]
  v_mfma_f32_16x16x32_bf16 v[112:115], v[200:203], v[164:167], v[112:115]
  v_mfma_f32_16x16x32_bf16 v[108:111], v[236:239], v[176:179], v[108:111]
  v_mfma_f32_16x16x32_bf16 v[112:115], v[236:239], v[180:183], v[112:115]
  s_waitcnt lgkmcnt(0)
  v_mfma_f32_16x16x32_bf16 v[116:119], v[248:251], v[212:215], v[116:119]
  v_cvt_pk_bf16_f32 v64, v100, v101
  v_cvt_pk_bf16_f32 v65, v102, v103
  v_cvt_pk_bf16_f32 v66, v104, v105
  v_cvt_pk_bf16_f32 v67, v106, v107
  buffer_store_dwordx4 v[64:67], v1, s[40:43], s54 offen offset:2048 sc1
  v_cvt_pk_bf16_f32 v68, v108, v109
  v_cvt_pk_bf16_f32 v69, v110, v111
  v_cvt_pk_bf16_f32 v70, v112, v113
  v_cvt_pk_bf16_f32 v71, v114, v115
  buffer_store_dwordx4 v[68:71], v1, s[40:43], s54 offen offset:3072 sc1
  v_cvt_pk_bf16_f32 v72, v116, v117
  v_cvt_pk_bf16_f32 v73, v118, v119
  buffer_store_dwordx2 v[72:73], v29, s[40:43], s56 offen sc1
  s_lshl_b32 s54, s50, 5
  s_lshl_b32 s55, s48, 2
  s_add_u32 s54, s54, s55
  s_mul_i32 s53, s54, 36864
  s_and_b32 s56, s2, 31
  s_mul_i32 s54, s56, 1152
  s_add_u32 s53, s53, s54
  s_add_u32 s54, s53, 36864
  s_add_u32 s55, s53, 73728
  s_add_u32 s63, s53, 110592
  s_lshl_b32 s64, s50, 12
  s_lshl_b32 s56, s56, 2
  s_add_u32 s64, s64, s56
  s_add_u32 s64, s64, 0x1800000
  s_lshl_b32 s59, s2, 7
  s_lshl_b32 s56, s48, 4
  s_add_u32 s59, s59, s56
  s_add_u32 s59, s59, 0x1800000
  s_mul_i32 s100, s48, 3072
  s_add_u32 s100, s100, 65536
  v_lshlrev_b32 v31, 5, v0
  v_add_u32 v31, s100, v31
  s_waitcnt vmcnt(0)
  s_barrier
  s_cmp_lg_u32 s48, 0
  s_cbranch_scc1 Lfl_27
  s_mov_b32 exec_hi, 0
  buffer_store_dword v33, v13, s[40:43], s64 offen sc1
  s_mov_b64 exec, -1
Lfl_27:
  s_mov_b32 s56, 0x20000
Lsm_28:
  buffer_load_dword v28, v14, s[40:43], s59 offen sc1
  s_waitcnt vmcnt(0)
  v_cmp_ne_u32 vcc, v28, v33
  s_nop 3
  s_cbranch_vccz Lsmd_29
  s_sub_u32 s56, s56, 1
  s_cmp_eq_u32 s56, 0
  s_cbranch_scc1 Lsmd_29
  s_sleep 1
  s_branch Lsm_28
Lsmd_29:
  buffer_load_dwordx4 v[128:131], v1, s[40:43], s53 offen sc1
  buffer_load_dwordx4 v[132:135], v1, s[40:43], s54 offen sc1
  buffer_load_dwordx4 v[136:139], v1, s[40:43], s55 offen sc1
  buffer_load_dwordx4 v[140:143], v1, s[40:43], s63 offen sc1
  buffer_load_dwordx4 v[144:147], v12, s[40:43], s53 offen sc1
  s_mov_b32 s56, 0xffff0000
  s_waitcnt vmcnt(4)
  v_lshlrev_b32 v160, 16, v128
  v_and_b32 v161, s56, v128
  v_lshlrev_b32 v162, 16, v129
  v_and_b32 v163, s56, v129
  v_lshlrev_b32 v164, 16, v130
  v_and_b32 v165, s56, v130
  v_lshlrev_b32 v166, 16, v131
  v_and_b32 v167, s56, v131
  s_waitcnt vmcnt(3)
  v_lshlrev_b32 v176, 16, v132
  v_and_b32 v177, s56, v132
  v_lshlrev_b32 v178, 16, v133
  v_and_b32 v179, s56, v133
  v_lshlrev_b32 v180, 16, v134
  v_and_b32 v181, s56, v134
  v_lshlrev_b32 v182, 16, v135
  v_and_b32 v183, s56, v135
  v_pk_add_f32 v[160:161], v[160:161], v[176:177]
  v_pk_add_f32 v[162:163], v[162:163], v[178:179]
  v_pk_add_f32 v[164:165], v[164:165], v[180:181]
  v_pk_add_f32 v[166:167], v[166:167], v[182:183]
  s_waitcnt vmcnt(2)
  v_lshlrev_b32 v176, 16, v136
  v_and_b32 v177, s56, v136
  v_lshlrev_b32 v178, 16, v137
  v_and_b32 v179, s56, v137
  v_lshlrev_b32 v180, 16, v138
  v_and_b32 v181, s56, v138
  v_lshlrev_b32 v182, 16, v139
  v_and_b32 v183, s56, v139
  v_pk_add_f32 v[160:161], v[160:161], v[176:177]
  v_pk_add_f32 v[162:163], v[162:163], v[178:179]
  v_pk_add_f32 v[164:165], v[164:165], v[180:181]
  v_pk_add_f32 v[166:167], v[166:167], v[182:183]
  s_waitcnt vmcnt(1)
  v_lshlrev_b32 v176, 16, v140
  v_and_b32 v177, s56, v140
  v_lshlrev_b32 v178, 16, v141
  v_and_b32 v179, s56, v141
  v_lshlrev_b32 v180, 16, v142
  v_and_b32 v181, s56, v142
  v_lshlrev_b32 v182, 16, v143
  v_and_b32 v183, s56, v143
  v_pk_add_f32 v[160:161], v[160:161], v[176:177]
  v_pk_add_f32 v[162:163], v[162:163], v[178:179]
  v_pk_add_f32 v[164:165], v[164:165], v[180:181]
  v_pk_add_f32 v[166:167], v[166:167], v[182:183]
  ds_write_b128 v31, v[160:163]
  ds_write_b128 v31, v[164:167] offset:16
  s_waitcnt vmcnt(0)
  v_lshlrev_b32 v168, 16, v144
  v_and_b32 v169, s56, v144
  v_lshlrev_b32 v170, 16, v145
  v_and_b32 v171, s56, v145
  v_lshlrev_b32 v172, 16, v146
  v_and_b32 v173, s56, v146
  v_lshlrev_b32 v174, 16, v147
  v_and_b32 v175, s56, v147
  s_mov_b32 exec_hi, 0
  ds_write_b128 v31, v[168:171] offset:2048
  ds_write_b128 v31, v[172:175] offset:2064
  s_mov_b64 exec, -1
  s_waitcnt lgkmcnt(0)
  s_barrier
  s_cmp_ge_u32 s48, 6
  s_cbranch_scc1 L_end1
  ds_read_b64 v[128:129], v11 offset:0
  ds_read_b64 v[130:131], v11 offset:3072
  ds_read_b64 v[132:133], v11 offset:6144
  ds_read_b64 v[134:135], v11 offset:9216
  ds_read_b64 v[136:137], v11 offset:12288
  ds_read_b64 v[138:139], v11 offset:15360
  ds_read_b64 v[140:141], v11 offset:18432
  ds_read_b64 v[142:143], v11 offset:21504
  s_waitcnt lgkmcnt(6)
  v_pk_add_f32 v[128:129], v[128:129], v[130:131]
  s_waitcnt lgkmcnt(5)
  v_pk_add_f32 v[128:129], v[128:129], v[132:133]
  s_waitcnt lgkmcnt(4)
  v_pk_add_f32 v[128:129], v[128:129], v[134:135]
  s_waitcnt lgkmcnt(3)
  v_pk_add_f32 v[128:129], v[128:129], v[136:137]
  s_waitcnt lgkmcnt(2)
  v_pk_add_f32 v[128:129], v[128:129], v[138:139]
  s_waitcnt lgkmcnt(1)
  v_pk_add_f32 v[128:129], v[128:129], v[140:141]
  s_waitcnt lgkmcnt(0)
  v_pk_add_f32 v[128:129], v[128:129], v[142:143]
  s_cmp_lt_u32 s48, 4
  s_cbranch_scc1 Lq_30
  v_add_f32_dpp v128, v128, v128 quad_perm:[1,0,3,2] row_mask:0xf bank_mask:0xf
  v_add_f32_dpp v129, v129, v129 quad_perm:[1,0,3,2] row_mask:0xf bank_mask:0xf
  s_nop 0
  v_add_f32_dpp v128, v128, v128 quad_perm:[2,3,0,1] row_mask:0xf bank_mask:0xf
  v_add_f32_dpp v129, v129, v129 quad_perm:[2,3,0,1] row_mask:0xf bank_mask:0xf
Lq_30:
  v_cvt_pk_bf16_f32 v128, v128, v129
  buffer_store_dword v128, v10, s[28:31], 0 offen
L_end1:
  s_endpgm
.section .rodata,"a"
.p2align 6
.amdhsa_kernel standalone__sliding_block_cached__sampling_kernel
  .amdhsa_next_free_vgpr 256
  .amdhsa_next_free_sgpr 102
  .amdhsa_accum_offset 256
  .amdhsa_group_segment_fixed_size 0
  .amdhsa_kernarg_size 64
  .amdhsa_user_sgpr_count 2
  .amdhsa_user_sgpr_kernarg_segment_ptr 1
  .amdhsa_system_sgpr_workgroup_id_x 1
.end_amdhsa_kernel
```
